```python
import torch

def _softmax(x, axis=-1):
    return torch.softmax(x, dim=axis)
def _gelu(x):
    return torch.nn.functional.gelu(x, approximate="tanh")
def _silu(x):
    return torch.nn.functional.silu(x)
def _sigmoid(x):
    return torch.sigmoid(x)
def _layernorm(x, axis=-1, eps=1e-5):
    m = x.mean(dim=axis, keepdim=True)
    v = x.var(dim=axis, keepdim=True, unbiased=False)
    return (x - m) / torch.sqrt(v + eps)
def _scatter_add(tgt, idx, src, axis=0):
    return tgt.clone().index_add_(axis, idx, src)
def _segment_sum(src, seg, n):
    out = torch.zeros((n,) + src.shape[1:], dtype=src.dtype)
    return out.index_add_(0, seg, src)
def _pad(x, pw):
    flat = tuple(v for pair in reversed(pw) for v in pair)
    return torch.nn.functional.pad(x, flat)

kernel_name = 'sequential_preLN__sliding_block_cached__glu_gated_reglu__decode'

def setup_inputs():

    _w = (lambda a: (lambda t: t.to(torch.bfloat16) if t.is_floating_point() else t)(torch.as_tensor(a)))
    def _A_setup():
        B, Sq, D = 1, 1, 512
        Hq, Hkv, Sk, Dh = 32, 8, 32768, 128
        assert Hq % Hkv == 0, (Hq, Hkv)
        return {
            "x": _w((lambda *s: torch.randn(*s, dtype=torch.bfloat16) * 0.05)(B, Sq, D)),
            "k_cache": _w((lambda *s: torch.randn(*s, dtype=torch.bfloat16) * 1.6)(B, Hkv, Sk, Dh)),
            "v_cache": _w((lambda *s: torch.randn(*s, dtype=torch.bfloat16) * 0.8)(B, Hkv, Sk, Dh)),
            "wq": _w((lambda *s: torch.randn(*s, dtype=torch.bfloat16) * 1.6)(D, Hq * Dh) * (D ** -0.5)),
            "wo": _w((lambda *s: torch.randn(*s, dtype=torch.bfloat16) * 0.8)(Hq * Dh, D) * ((Hq * Dh) ** -0.5)),
        }
    _A_in = _A_setup()

    def _B_setup():
        B, S, D, F = 1, 1, 512, 1792
        return {
            "x": _w((lambda *s: torch.randn(*s, dtype=torch.bfloat16) * 0.05)(B, S, D)),
            "W_gate": _w((lambda *s: torch.randn(*s, dtype=torch.bfloat16) * 0.4)(D, F) * (2.0 / D) ** 0.5),
            "W_up": _w((lambda *s: torch.randn(*s, dtype=torch.bfloat16) * 0.4)(D, F) * (2.0 / D) ** 0.5),
            "W_down": _w((lambda *s: torch.randn(*s, dtype=torch.bfloat16) * 0.4)(F, D) * (1.0 / F) ** 0.5),
        }
    _B_in = _B_setup()

    return {
        "A_x": _A_in["x"],
        "A_k_cache": _A_in["k_cache"],
        "A_v_cache": _A_in["v_cache"],
        "A_wq": _A_in["wq"],
        "A_wo": _A_in["wo"],
        "B_x": _B_in["x"],
        "B_W_gate": _B_in["W_gate"],
        "B_W_up": _B_in["W_up"],
        "B_W_down": _B_in["W_down"],
    }

def reference(A_x, A_k_cache, A_v_cache, A_wq, A_wo, B_x, B_W_gate, B_W_up, B_W_down):
    def _A_ref(x, k_cache, v_cache, wq, wo):
        B, Sq, D = x.shape
        Hq, Dh = 32, 128
        Hkv, Sk = k_cache.shape[1], k_cache.shape[2]
        W = min(4096, max(256, Sk // 4))
        rep = Hq // Hkv
        q = (lambda x, *d: x.permute(*d))((x @ wq).reshape(B, Sq, Hq, Dh), 0, 2, 1, 3)
        k = (lambda x, n, axis: torch.repeat_interleave(x, n, dim=axis))(k_cache[:, :, Sk - W:, :], rep, axis=1)
        v = (lambda x, n, axis: torch.repeat_interleave(x, n, dim=axis))(v_cache[:, :, Sk - W:, :], rep, axis=1)
        scores = torch.einsum("bhqd,bhkd->bhqk", q, k) * (Dh ** -0.5)
        p = _softmax(scores, axis=-1)
        o = torch.einsum("bhqk,bhkd->bhqd", p, v)
        return (lambda x, *d: x.permute(*d))(o, 0, 2, 1, 3).reshape(B, Sq, Hq * Dh) @ wo

    def _B_ref(x, W_gate, W_up, W_down):
        gate = torch.einsum("bsd,df->bsf", x, W_gate)
        up = torch.einsum("bsd,df->bsf", x, W_up)
        gate = gate * (lambda x, dt: x.to(dt))(gate > 0, gate.dtype)
        h = gate * up
        return torch.einsum("bsf,fd->bsd", h, W_down)

    x = A_x
    h = x + _A_ref(_layernorm(x, axis=-1), A_k_cache, A_v_cache, A_wq, A_wo)
    h2 = h + _B_ref(_layernorm(h, axis=-1), B_W_gate, B_W_up, B_W_down)
    return h2
```

```asm
; @launch grid=(256,1,1) block=(640,1,1) lds=129408
.amdgcn_target "amdgcn-amd-amdhsa--gfx950"
.text
.globl sequential_preLN__sliding_block_cached__glu_gated_reglu__decode_kernel
.p2align 8
.type sequential_preLN__sliding_block_cached__glu_gated_reglu__decode_kernel,@function
sequential_preLN__sliding_block_cached__glu_gated_reglu__decode_kernel:
L_entry:
    s_cmp_ge_u32 s2, 256
    s_cbranch_scc1 L_exit
    s_load_dwordx16 s[64:79], s[0:1], 0
    s_load_dwordx8 s[80:87], s[0:1], 64
    v_lshrrev_b32 v1, 6, v0
    v_and_b32 v0, 63, v0
    s_and_b32 s4, s2, 7
    v_readfirstlane_b32 s3, v1
    s_lshr_b32 s5, s2, 3
    v_lshrrev_b32 v3, 4, v0
    v_and_b32 v4, 15, v0
    v_mov_b32 v124, 128512
    s_cmp_lg_u32 s3, 0
    s_cbranch_scc1 L_notloader
    s_setprio 2
    v_lshlrev_b32 v5, 1, v3
    v_and_b32 v6, 7, v0
    v_xor_b32 v5, v5, v6
    v_lshlrev_b32 v5, 4, v5
    v_lshrrev_b32 v6, 3, v0
    v_lshl_add_u32 v5, v6, 13, v5
    v_add_u32 v6, 64512, v5
    v_add_u32 v7, 129024, v5
    v_add_u32 v8, 193536, v5
    s_lshr_b32 s60, s5, 3
    s_and_b32 s61, s5, 7
    s_lshl_b32 s54, s60, 20
    s_lshl_b32 s55, s4, 10
    s_add_u32 s54, s54, s55
    s_lshl_b32 s55, s61, 7
    s_add_u32 s54, s54, s55
    v_mov_b32 v20, 0
    v_lshl_add_u32 v16, v0, 2, v124
    ds_write_b32 v16, v20
    s_mov_b32 s22, 4194304
    s_mov_b32 s23, 0x00020000
    s_waitcnt lgkmcnt(0)
    s_mov_b64 s[20:21], s[70:71]
    s_mov_b32 m0, 98304
    s_nop 0
    buffer_load_dwordx4 v5, s[20:23], s54 offen offset:0 nt lds
    buffer_load_dwordx4 v6, s[20:23], s54 offen offset:1024 nt lds
    buffer_load_dwordx4 v7, s[20:23], s54 offen offset:2048 nt lds
    buffer_load_dwordx4 v8, s[20:23], s54 offen offset:3072 nt lds
    s_add_u32 s54, s54, 262144
    s_mov_b32 m0, 102400
    s_nop 0
    buffer_load_dwordx4 v5, s[20:23], s54 offen offset:0 nt lds
    buffer_load_dwordx4 v6, s[20:23], s54 offen offset:1024 nt lds
    buffer_load_dwordx4 v7, s[20:23], s54 offen offset:2048 nt lds
    buffer_load_dwordx4 v8, s[20:23], s54 offen offset:3072 nt lds
    s_add_u32 s54, s54, 262144
    s_mov_b32 m0, 106496
    s_nop 0
    buffer_load_dwordx4 v5, s[20:23], s54 offen offset:0 nt lds
    buffer_load_dwordx4 v6, s[20:23], s54 offen offset:1024 nt lds
    buffer_load_dwordx4 v7, s[20:23], s54 offen offset:2048 nt lds
    buffer_load_dwordx4 v8, s[20:23], s54 offen offset:3072 nt lds
    s_add_u32 s54, s54, 262144
    s_mov_b32 m0, 110592
    s_nop 0
    buffer_load_dwordx4 v5, s[20:23], s54 offen offset:0 nt lds
    buffer_load_dwordx4 v6, s[20:23], s54 offen offset:1024 nt lds
    buffer_load_dwordx4 v7, s[20:23], s54 offen offset:2048 nt lds
    buffer_load_dwordx4 v8, s[20:23], s54 offen offset:3072 nt lds
    s_add_u32 s54, s54, 262144
    s_barrier
    s_branch L_loader2
L_notloader:
    v_lshlrev_b32 v2, 4, v0
    v_mov_b32 v125, 1
    s_mov_b32 s50, 0xffffff00
    s_mov_b32 s10, 1024
    s_mov_b32 s11, 0x00020000
    s_mov_b32 s46, 5242880
    s_mov_b32 s47, 0x00020000
    s_cmp_eq_u32 s3, 1
    s_cbranch_scc1 L_helper
    s_cmp_lg_u32 s3, 9
    s_cbranch_scc1 L_nopf
    s_getpc_b64 s[94:95]
L_pc:
    s_sub_u32 s94, s94, L_pc-L_entry
    s_subb_u32 s95, s95, 0
    v_lshlrev_b32 v5, 7, v0
    s_lshl_b32 s54, s5, 9
    v_add_u32 v5, s54, v5
    v_min_u32 v5, L_exit-L_entry, v5
    s_mov_b64 exec, 0xf
    global_load_dword v122, v5, s[94:95]
    s_mov_b64 exec, -1
L_nopf:
    s_barrier
    s_branch L_worker
L_helper:
    s_setprio 3
    s_lshr_b32 s60, s5, 3
    s_and_b32 s61, s5, 7
    v_lshlrev_b32 v7, 2, v0
    s_lshl_b32 s62, s60, 8
    s_waitcnt lgkmcnt(0)
    s_mov_b64 s[8:9], s[64:65]
    buffer_load_dwordx4 v[8:11], v2, s[8:11], 0 offen
    buffer_load_dword v12, v7, s[8:11], s62 offen
    s_mov_b32 s42, 1024
    s_mov_b32 s43, 0x00020000
    s_mov_b64 s[44:45], s[86:87]
    s_mov_b64 s[40:41], s[82:83]
    s_load_dword s7, s[44:45], 0
    s_lshl_b32 s54, s4, 13
    s_lshl_b32 s55, s60, 11
    s_add_u32 s55, s55, s54
    s_lshl_b32 s56, s61, 8
    s_add_u32 s55, s55, s56
    s_add_u32 s55, s55, 4096
    s_lshl_b32 s12, s4, 11
    s_lshl_b32 s56, s5, 4
    s_add_u32 s13, s12, s56
    s_add_u32 s13, s13, 69632
    v_lshrrev_b32 v5, 2, v0
    v_bfe_u32 v6, v0, 3, 2
    v_lshlrev_b32 v6, 5, v6
    v_lshl_add_u32 v6, v5, 7, v6
    v_and_b32 v13, 3, v0
    v_lshl_add_u32 v6, v13, 3, v6
    v_add_u32 v28, 98304, v6
    v_xor_b32 v29, 32, v28
    v_xor_b32 v30, 64, v28
    v_xor_b32 v31, 96, v28
    v_lshlrev_b32 v5, 3, v3
    v_add_u32 v5, 114688, v5
    v_add_u32 v6, 114688, v7
    v_mov_b32 v13, 0x3f803f80
    v_cmp_eq_u32 s[56:57], 1, v3
    v_cmp_eq_u32 s[58:59], 2, v3
    v_cmp_eq_u32 s[60:61], 3, v3
    s_barrier
    s_waitcnt vmcnt(1)
    v_dot2_f32_bf16 v20, v8, v13, 0
    v_dot2_f32_bf16 v21, v8, v8, 0
    v_dot2_f32_bf16 v20, v9, v13, v20
    v_dot2_f32_bf16 v21, v9, v9, v21
    v_dot2_f32_bf16 v20, v10, v13, v20
    v_dot2_f32_bf16 v21, v10, v10, v21
    v_dot2_f32_bf16 v20, v11, v13, v20
    v_dot2_f32_bf16 v21, v11, v11, v21
    s_nop 1
    v_add_f32_dpp v20, v20, v20 quad_perm:[1,0,3,2] row_mask:0xf bank_mask:0xf
    v_add_f32_dpp v21, v21, v21 quad_perm:[1,0,3,2] row_mask:0xf bank_mask:0xf
    s_nop 0
    v_add_f32_dpp v20, v20, v20 quad_perm:[2,3,0,1] row_mask:0xf bank_mask:0xf
    v_add_f32_dpp v21, v21, v21 quad_perm:[2,3,0,1] row_mask:0xf bank_mask:0xf
    s_nop 0
    v_add_f32_dpp v20, v20, v20 row_half_mirror row_mask:0xf bank_mask:0xf
    v_add_f32_dpp v21, v21, v21 row_half_mirror row_mask:0xf bank_mask:0xf
    s_nop 0
    v_add_f32_dpp v20, v20, v20 row_mirror row_mask:0xf bank_mask:0xf
    v_add_f32_dpp v21, v21, v21 row_mirror row_mask:0xf bank_mask:0xf
    v_mov_b32 v22, v20
    v_mov_b32 v23, v21
    s_nop 0
    v_permlane16_swap_b32 v20, v22
    v_permlane16_swap_b32 v21, v23
    v_pk_add_f32 v[20:21], v[20:21], v[22:23]
    v_mov_b32 v22, v20
    v_mov_b32 v23, v21
    s_nop 0
    v_permlane32_swap_b32 v20, v22
    v_permlane32_swap_b32 v21, v23
    v_pk_add_f32 v[20:21], v[20:21], v[22:23]
    v_mul_f32 v20, 0x3b000000, v20
    v_mul_f32 v21, 0x3b000000, v21
    v_fma_f32 v21, -v20, v20, v21
    v_max_f32 v21, 0, v21
    v_cvt_pk_bf16_f32 v22, v20, v21
    v_lshlrev_b32 v20, 16, v22
    v_and_b32 v21, 0xffff0000, v22
    v_add_f32 v21, 0x3727c5ac, v21
    v_cvt_pk_bf16_f32 v21, v21, v21
    v_and_b32 v21, 0xffff0000, v21
    v_sqrt_f32 v21, v21
    s_waitcnt vmcnt(0)
    v_lshlrev_b32 v14, 16, v12
    v_cvt_pk_bf16_f32 v21, v21, v21
    v_and_b32 v15, 0xffff0000, v12
    v_and_b32 v21, 0xffff0000, v21
    v_rcp_f32 v21, v21
    v_sub_f32 v14, v14, v20
    v_sub_f32 v15, v15, v20
    v_cvt_pk_bf16_f32 v12, v14, v15
    v_lshlrev_b32 v14, 16, v12
    v_and_b32 v15, 0xffff0000, v12
    v_pk_mul_f32 v[14:15], v[14:15], v[20:21] op_sel:[0,1] op_sel_hi:[1,1]
    v_cvt_pk_bf16_f32 v12, v14, v15
    ds_write_b32 v6, v12
    ds_read2_b64 v[12:15], v5 offset0:0 offset1:4
    ds_read2_b64 v[16:19], v5 offset0:8 offset1:12
    ds_read2_b64 v[20:23], v5 offset0:16 offset1:20
    ds_read2_b64 v[24:27], v5 offset0:24 offset1:28
    s_mov_b32 s53, 1048576
Lw_1:
    ds_read_b32 v123, v124 offset:16
    s_sub_u32 s53, s53, 1
    s_cbranch_scc1 Lwd_2
    s_waitcnt lgkmcnt(0)
    v_cmp_gt_u32 vcc, 2, v123
    s_cbranch_vccnz Lw_1
Lwd_2:
    ds_read_b64_tr_b16 v[32:33], v28 offset:0
    ds_read_b64_tr_b16 v[34:35], v28 offset:2048
    ds_read_b64_tr_b16 v[36:37], v29 offset:0
    ds_read_b64_tr_b16 v[38:39], v29 offset:2048
    ds_read_b64_tr_b16 v[40:41], v30 offset:0
    ds_read_b64_tr_b16 v[42:43], v30 offset:2048
    ds_read_b64_tr_b16 v[44:45], v31 offset:0
    ds_read_b64_tr_b16 v[46:47], v31 offset:2048
    ds_read_b64_tr_b16 v[48:49], v28 offset:4096
    ds_read_b64_tr_b16 v[50:51], v28 offset:6144
    ds_read_b64_tr_b16 v[52:53], v29 offset:4096
    ds_read_b64_tr_b16 v[54:55], v29 offset:6144
    ds_read_b64_tr_b16 v[56:57], v30 offset:4096
    ds_read_b64_tr_b16 v[58:59], v30 offset:6144
    ds_read_b64_tr_b16 v[60:61], v31 offset:4096
    ds_read_b64_tr_b16 v[62:63], v31 offset:6144
    s_add_u32 s7, s7, 1
    s_and_b32 s6, s7, 0xff
    v_mov_b32 v1, s6
    s_mul_i32 s51, s7, 0x9E3779B1
    s_xor_b32 s51, s51, 0x5bd1e995
    s_mul_i32 s52, s7, 0x85EBCA77
    s_xor_b32 s52, s52, 0xc2b2ae3d
    s_getreg_b32 s62, hwreg(HW_REG_XCC_ID)
    s_and_b32 s62, s62, 7
    s_lshl_b32 s62, s62, 5
    s_xor_b32 s62, s62, s6
    v_mov_b32 v121, s62
    s_mov_b32 s19, 0x200000
    s_waitcnt lgkmcnt(0)
    v_mfma_f32_16x16x32_bf16 v[96:99], v[12:15], v[32:35], 0
    v_mfma_f32_16x16x32_bf16 v[100:103], v[12:15], v[36:39], 0
    v_mfma_f32_16x16x32_bf16 v[104:107], v[12:15], v[40:43], 0
    v_mfma_f32_16x16x32_bf16 v[108:111], v[12:15], v[44:47], 0
    v_mfma_f32_16x16x32_bf16 v[96:99], v[16:19], v[48:51], v[96:99]
    v_mfma_f32_16x16x32_bf16 v[100:103], v[16:19], v[52:55], v[100:103]
    v_mfma_f32_16x16x32_bf16 v[104:107], v[16:19], v[56:59], v[104:107]
    v_mfma_f32_16x16x32_bf16 v[108:111], v[16:19], v[60:63], v[108:111]
    s_mov_b32 s53, 1048576
Lw_3:
    ds_read_b32 v123, v124 offset:16
    s_sub_u32 s53, s53, 1
    s_cbranch_scc1 Lwd_4
    s_waitcnt lgkmcnt(0)
    v_cmp_gt_u32 vcc, 4, v123
    s_cbranch_vccnz Lw_3
Lwd_4:
    ds_read_b64_tr_b16 v[64:65], v28 offset:8192
    ds_read_b64_tr_b16 v[66:67], v28 offset:10240
    ds_read_b64_tr_b16 v[68:69], v29 offset:8192
    ds_read_b64_tr_b16 v[70:71], v29 offset:10240
    ds_read_b64_tr_b16 v[72:73], v30 offset:8192
    ds_read_b64_tr_b16 v[74:75], v30 offset:10240
    ds_read_b64_tr_b16 v[76:77], v31 offset:8192
    ds_read_b64_tr_b16 v[78:79], v31 offset:10240
    ds_read_b64_tr_b16 v[80:81], v28 offset:12288
    ds_read_b64_tr_b16 v[82:83], v28 offset:14336
    ds_read_b64_tr_b16 v[84:85], v29 offset:12288
    ds_read_b64_tr_b16 v[86:87], v29 offset:14336
    ds_read_b64_tr_b16 v[88:89], v30 offset:12288
    ds_read_b64_tr_b16 v[90:91], v30 offset:14336
    ds_read_b64_tr_b16 v[92:93], v31 offset:12288
    ds_read_b64_tr_b16 v[94:95], v31 offset:14336
    s_waitcnt lgkmcnt(14)
    v_mfma_f32_16x16x32_bf16 v[96:99], v[20:23], v[64:67], v[96:99]
    s_waitcnt lgkmcnt(12)
    v_mfma_f32_16x16x32_bf16 v[100:103], v[20:23], v[68:71], v[100:103]
    s_waitcnt lgkmcnt(10)
    v_mfma_f32_16x16x32_bf16 v[104:107], v[20:23], v[72:75], v[104:107]
    s_waitcnt lgkmcnt(8)
    v_mfma_f32_16x16x32_bf16 v[108:111], v[20:23], v[76:79], v[108:111]
    s_waitcnt lgkmcnt(6)
    v_mfma_f32_16x16x32_bf16 v[96:99], v[24:27], v[80:83], v[96:99]
    s_waitcnt lgkmcnt(4)
    v_mfma_f32_16x16x32_bf16 v[100:103], v[24:27], v[84:87], v[100:103]
    s_waitcnt lgkmcnt(2)
    v_mfma_f32_16x16x32_bf16 v[104:107], v[24:27], v[88:91], v[104:107]
    s_waitcnt lgkmcnt(0)
    v_mfma_f32_16x16x32_bf16 v[108:111], v[24:27], v[92:95], v[108:111]
    s_nop 3
    v_cndmask_b32 v96, v96, v100, s[56:57]
    s_nop 0
    v_cndmask_b32 v96, v96, v104, s[58:59]
    s_nop 0
    v_cndmask_b32 v96, v96, v108, s[60:61]
    v_bfi_b32 v97, s50, v96, v121
    buffer_store_dword v97, v7, s[44:47], s55 offen
    v_bfi_b32 v96, s50, v96, v1
    s_add_u32 s62, s55, s19
    buffer_store_dword v96, v7, s[44:47], s62 offen sc1
    ds_write_b32 v124, v125 offset:32
    s_setprio 0
    v_and_b32 v9, 3, v0
    v_lshlrev_b32 v13, 5, v9
    v_add_u32 v13, 128768, v13
    v_lshlrev_b32 v15, 9, v9
    v_mov_b32 v26, s51
    v_mov_b32 v27, s52
    s_lshr_b32 s55, s5, 4
    s_lshl_b32 s55, s55, 10
    s_add_u32 s54, s12, s55
    s_add_u32 s54, s54, 69632
    s_mov_b32 s58, 1069066811
    v_add_u32 v6, 129024, v7
    s_sub_u32 s60, s5, 16
    v_and_b32 v5, 31, v0
    v_lshlrev_b32 v16, 1, v5
    s_lshl_b32 s14, s60, 6
    v_mov_b32 v30, 0
    s_cmp_lt_u32 s5, 16
    s_cbranch_scc1 L_h_nox2
    buffer_load_ushort v30, v16, s[8:11], s14 offen
L_h_nox2:
    s_mov_b32 s53, 1048576
Lw_5:
    s_sleep 1
    ds_read_b32 v123, v124 offset:12
    s_sub_u32 s53, s53, 1
    s_cbranch_scc1 Lwd_6
    s_waitcnt lgkmcnt(0)
    v_cmp_gt_u32 vcc, 8, v123
    s_cbranch_vccnz Lw_5
Lwd_6:
    ds_read_b128 v[96:99], v13
    ds_read_b128 v[100:103], v13 offset:16
    ds_read_b128 v[104:107], v13 offset:128
    ds_read_b128 v[108:111], v13 offset:144
    ds_read_b32 v112, v124 offset:40
    s_waitcnt lgkmcnt(0)
    v_readfirstlane_b32 s49, v112
    s_cmp_eq_u32 s49, 0
    s_cselect_b32 s48, 0, -1
    v_max3_f32 v24, v96, v97, v98
    v_max3_f32 v25, v99, v100, v101
    v_max3_f32 v24, v24, v102, v103
    v_max_f32 v24, v24, v25
    v_pk_add_f32 v[104:105], v[104:105], v[106:107]
    v_pk_add_f32 v[108:109], v[108:109], v[110:111]
    v_pk_add_f32 v[104:105], v[104:105], v[108:109]
    v_add_f32 v25, v104, v105
    s_mov_b64 exec, 0xf
    v_bfi_b32 v24, s50, v24, v1
    v_bfi_b32 v25, s50, v25, v1
    buffer_store_dwordx4 v[24:27], v15, s[44:47], s13 offen
    s_cmp_eq_u32 s49, 0
    s_cbranch_scc1 Lpb_7
    s_add_u32 s62, s13, s19
    buffer_store_dwordx4 v[24:27], v15, s[44:47], s62 offen sc1
Lpb_7:
    s_mov_b64 exec, -1
    buffer_load_dwordx4 v[8:11], v2, s[44:47], s54 offen sc1
    s_mov_b32 s63, 262144
Lpc_10:
    s_waitcnt vmcnt(0)
    v_xor_b32 v8, v8, v1
    v_xor_b32 v9, v9, v1
    v_xor_b32 v10, s51, v10
    v_xor_b32 v11, s52, v11
    v_bitop3_b32 v12, v8, v9, s50 bitop3:0x54
    v_or3_b32 v12, v12, v10, v11
    v_cmp_ne_u32 vcc, 0, v12
    s_cbranch_vccnz Lpr_9
Lpd_8:
    v_mov_b32 v14, v8
    s_nop 1
    v_max_f32_dpp v14, v14, v14 quad_perm:[1,0,3,2] row_mask:0xf bank_mask:0xf
    s_nop 1
    v_max_f32_dpp v14, v14, v14 quad_perm:[2,3,0,1] row_mask:0xf bank_mask:0xf
    s_nop 1
    v_max_f32_dpp v14, v14, v14 row_half_mirror row_mask:0xf bank_mask:0xf
    s_nop 1
    v_max_f32_dpp v14, v14, v14 row_mirror row_mask:0xf bank_mask:0xf
    v_mov_b32 v15, v14
    s_nop 1
    v_permlane16_swap_b32 v14, v15
    v_max_f32 v14, v14, v15
    v_sub_f32 v8, v8, v14
    v_mul_f32 v8, s58, v8
    v_exp_f32 v8, v8
    s_nop 0
    v_mul_f32 v9, v8, v9
    s_nop 1
    v_add_f32_dpp v9, v9, v9 quad_perm:[1,0,3,2] row_mask:0xf bank_mask:0xf
    s_nop 1
    v_add_f32_dpp v9, v9, v9 quad_perm:[2,3,0,1] row_mask:0xf bank_mask:0xf
    s_nop 1
    v_add_f32_dpp v9, v9, v9 row_half_mirror row_mask:0xf bank_mask:0xf
    s_nop 1
    v_add_f32_dpp v9, v9, v9 row_mirror row_mask:0xf bank_mask:0xf
    v_mov_b32 v15, v9
    s_nop 1
    v_permlane16_swap_b32 v9, v15
    v_add_f32 v9, v9, v15
    v_rcp_f32 v9, v9
    s_nop 0
    v_mul_f32 v8, v8, v9
    ds_write_b32 v6, v8
    ds_write_b32 v124, v125 offset:20
    s_barrier
    s_cmp_ge_u32 s5, 16
    s_cbranch_scc1 L_hf
    s_cmp_eq_u32 s4, 7
    s_cbranch_scc1 L_hend
    v_lshlrev_b32 v6, 4, v4
    s_lshl_b32 s54, s4, 8
    s_add_u32 s54, s54, 90112
    v_mov_b32 v7, 129280
    s_mov_b32 s53, 1048576
Lw_11:
    s_sleep 2
    ds_read_b32 v123, v124 offset:16
    s_sub_u32 s53, s53, 1
    s_cbranch_scc1 Lwd_12
    s_waitcnt lgkmcnt(0)
    v_cmp_gt_u32 vcc, 28, v123
    s_cbranch_vccnz Lw_11
Lwd_12:
    buffer_load_dwordx4 v[8:11], v6, s[44:47], s54 offen sc1
    s_mov_b32 s63, 262144
Lpc_15:
    s_waitcnt vmcnt(0)
    v_xor_b32 v8, v8, v1
    v_xor_b32 v9, v9, v1
    v_xor_b32 v10, s51, v10
    v_xor_b32 v11, s52, v11
    v_bitop3_b32 v12, v8, v9, s50 bitop3:0x54
    v_or3_b32 v12, v12, v10, v11
    v_cmp_ne_u32 vcc, 0, v12
    s_cbranch_vccnz Lpr_14
Lpd_13:
    v_add_f32_dpp v8, v8, v8 quad_perm:[1,0,3,2] row_mask:0xf bank_mask:0xf
    v_add_f32_dpp v9, v9, v9 quad_perm:[1,0,3,2] row_mask:0xf bank_mask:0xf
    s_nop 0
    v_add_f32_dpp v8, v8, v8 quad_perm:[2,3,0,1] row_mask:0xf bank_mask:0xf
    v_add_f32_dpp v9, v9, v9 quad_perm:[2,3,0,1] row_mask:0xf bank_mask:0xf
    s_nop 0
    v_add_f32_dpp v8, v8, v8 row_half_mirror row_mask:0xf bank_mask:0xf
    v_add_f32_dpp v9, v9, v9 row_half_mirror row_mask:0xf bank_mask:0xf
    s_nop 0
    v_add_f32_dpp v8, v8, v8 row_mirror row_mask:0xf bank_mask:0xf
    v_add_f32_dpp v9, v9, v9 row_mirror row_mask:0xf bank_mask:0xf
    v_mul_f32 v8, 0x3b000000, v8
    v_mul_f32 v9, 0x3b000000, v9
    v_fma_f32 v9, -v8, v8, v9
    v_max_f32 v9, 0, v9
    v_cvt_pk_bf16_f32 v10, v8, v9
    v_lshlrev_b32 v8, 16, v10
    v_and_b32 v9, 0xffff0000, v10
    v_add_f32 v9, 0x3727c5ac, v9
    v_cvt_pk_bf16_f32 v9, v9, v9
    v_and_b32 v9, 0xffff0000, v9
    v_sqrt_f32 v9, v9
    s_nop 0
    v_cvt_pk_bf16_f32 v9, v9, v9
    v_and_b32 v9, 0xffff0000, v9
    v_rcp_f32 v9, v9
    s_nop 0
    ds_write_b64 v7, v[8:9]
    s_waitcnt lgkmcnt(0)
    s_barrier
L_hend:
    s_endpgm
Lpr_9:
    s_cmp_lt_u32 s63, s48
    s_cselect_b32 s62, s19, 0
    s_xor_b32 s54, s54, s62
    buffer_load_dwordx4 v[8:11], v2, s[44:47], s54 offen sc1
    s_sub_u32 s63, s63, 1
    s_cbranch_scc0 Lpc_10
    s_waitcnt vmcnt(0)
    s_branch Lpd_8
Lpr_14:
    s_cmp_lt_u32 s63, s48
    s_cselect_b32 s62, s19, 0
    s_xor_b32 s54, s54, s62
    buffer_load_dwordx4 v[8:11], v6, s[44:47], s54 offen sc1
    s_sub_u32 s63, s63, 1
    s_cbranch_scc0 Lpc_15
    s_waitcnt vmcnt(0)
    s_branch Lpd_13
L_hf:
    v_lshrrev_b32 v7, 1, v5
    v_mul_u32_u24 v7, 80, v7
    v_and_b32 v8, 1, v0
    v_lshl_add_u32 v7, v8, 5, v7
    v_add_u32 v7, 123392, v7
    s_lshl_b32 s55, s60, 4
    s_lshl_b32 s56, s4, 8
    s_add_u32 s55, s55, s56
    s_add_u32 s55, s55, 90112
    v_mov_b32 v28, 0
    v_mov_b32 v22, s7
    v_lshlrev_b32 v20, 16, v30
    s_barrier
    ds_read_b128 v[8:11], v7
    ds_read_b128 v[12:15], v7 offset:16
    s_waitcnt lgkmcnt(0)
    v_pk_add_f32 v[8:9], v[8:9], v[10:11]
    v_pk_add_f32 v[12:13], v[12:13], v[14:15]
    v_add_f32 v8, v8, v9
    v_add_f32 v12, v12, v13
    v_add_f32 v8, v8, v12
    v_cvt_pk_bf16_f32 v8, v8, v8
    v_and_b32 v8, 0xffff0000, v8
    v_add_f32 v8, v8, v20
    v_cvt_pk_bf16_f32 v8, v8, v8
    v_and_b32 v8, 0xffff0000, v8
    s_cmp_eq_u32 s4, 7
    s_cbranch_scc1 L_hfin
    v_mov_b32 v24, v8
    v_mul_f32 v25, v8, v8
    s_nop 0
    v_add_f32_dpp v24, v24, v24 quad_perm:[1,0,3,2] row_mask:0xf bank_mask:0xf
    v_add_f32_dpp v25, v25, v25 quad_perm:[1,0,3,2] row_mask:0xf bank_mask:0xf
    s_nop 0
    v_add_f32_dpp v24, v24, v24 quad_perm:[2,3,0,1] row_mask:0xf bank_mask:0xf
    v_add_f32_dpp v25, v25, v25 quad_perm:[2,3,0,1] row_mask:0xf bank_mask:0xf
    s_nop 0
    v_add_f32_dpp v24, v24, v24 row_half_mirror row_mask:0xf bank_mask:0xf
    v_add_f32_dpp v25, v25, v25 row_half_mirror row_mask:0xf bank_mask:0xf
    s_nop 0
    v_add_f32_dpp v24, v24, v24 row_mirror row_mask:0xf bank_mask:0xf
    v_add_f32_dpp v25, v25, v25 row_mirror row_mask:0xf bank_mask:0xf
    v_mov_b32 v10, v24
    v_mov_b32 v11, v25
    s_nop 0
    v_permlane16_swap_b32 v24, v10
    v_permlane16_swap_b32 v25, v11
    v_pk_add_f32 v[24:25], v[24:25], v[10:11]
    s_mov_b64 exec, 1
    v_bfi_b32 v24, s50, v24, v1
    v_bfi_b32 v25, s50, v25, v1
    buffer_store_dwordx4 v[24:27], v28, s[44:47], s55 offen
    s_cmp_eq_u32 s49, 0
    s_cbranch_scc1 Lpb_16
    s_add_u32 s62, s55, s19
    buffer_store_dwordx4 v[24:27], v28, s[44:47], s62 offen sc1
Lpb_16:
    s_mov_b64 exec, -1
    s_endpgm
L_hfin:
    v_mov_b32 v20, v8
    s_mov_b32 s56, -1
    s_mov_b32 s57, 0
    s_barrier
    ds_read_b128 v[8:11], v7 offset:2048
    ds_read_b96 v[12:14], v7 offset:2064
    s_waitcnt lgkmcnt(0)
    v_pk_add_f32 v[8:9], v[8:9], v[10:11]
    v_add_f32 v12, v12, v13
    v_add_f32 v8, v8, v9
    v_add_f32 v12, v12, v14
    v_add_f32 v8, v8, v12
    v_cvt_pk_bf16_f32 v8, v8, v8
    v_and_b32 v8, 0xffff0000, v8
    v_add_f32 v8, v8, v20
    v_cvt_pk_bf16_f32 v8, v8, v8
    s_mov_b64 exec, s[56:57]
    buffer_store_short v8, v16, s[40:43], s14 offen
    s_cmp_lg_u32 s60, 0
    s_cbranch_scc1 L_hend3
    s_mov_b64 exec, 1
    buffer_store_dword v22, v28, s[44:47], 0 offen
L_hend3:
    s_mov_b64 exec, -1
    s_endpgm
L_loader2:
    v_xor_b32 v9, v4, v3
    v_lshlrev_b32 v9, 4, v9
    v_lshl_add_u32 v9, v3, 8, v9
    v_xor_b32 v10, 64, v9
    v_xor_b32 v11, 128, v9
    v_xor_b32 v12, 192, v9
    s_lshl_b32 s57, s4, 23
    s_lshl_b32 s58, s5, 12
    s_add_u32 s57, s57, s58
    s_add_u32 s57, s57, 7340032
    s_mov_b32 s58, s57
    v_lshlrev_b32 v15, 1, v3
    v_xor_b32 v15, v4, v15
    v_lshlrev_b32 v15, 4, v15
    v_lshl_add_u32 v13, v3, 8, v15
    v_xor_b32 v14, 128, v13
    s_mov_b32 s14, 67108864
    s_mov_b32 s15, 0x00020000
    s_mov_b32 s18, 67108864
    s_mov_b32 s19, 0x00020000
    s_mov_b32 s46, 5242880
    s_mov_b32 s47, 0x00020000
    s_mov_b32 s26, 4194304
    s_mov_b32 s27, 0x00020000
    s_mov_b32 s30, 1835008
    s_mov_b32 s31, 0x00020000
    s_mov_b32 s34, 1835008
    s_mov_b32 s35, 0x00020000
    s_mov_b32 s38, 1835008
    s_mov_b32 s39, 0x00020000
    s_mov_b64 s[12:13], s[66:67]
    s_mov_b64 s[16:17], s[68:69]
    s_mov_b64 s[44:45], s[86:87]
    s_mov_b64 s[24:25], s[72:73]
    s_mov_b64 s[28:29], s[76:77]
    s_mov_b64 s[32:33], s[78:79]
    s_mov_b64 s[36:37], s[80:81]
    v_lshl_add_u32 v5, v3, 10, v15
    v_xor_b32 v6, 128, v5
    v_add_u32 v6, 3072, v6
    v_add_u32 v7, 6144, v5
    v_add_u32 v8, 6144, v6
    s_lshl_b32 s54, s4, 19
    s_lshr_b32 s55, s5, 4
    s_lshl_b32 s55, s55, 18
    s_add_u32 s54, s54, s55
    s_bfe_u32 s55, s5, 0x20002
    s_lshl_b32 s55, s55, 15
    s_add_u32 s54, s54, s55
    s_and_b32 s55, s5, 3
    s_lshl_b32 s55, s55, 8
    s_add_u32 s54, s54, s55
    v_lshrrev_b32 v17, 5, v0
    v_and_b32 v18, 31, v0
    v_lshlrev_b32 v19, 1, v17
    v_xor_b32 v18, v18, v19
    v_lshlrev_b32 v18, 4, v18
    s_waitcnt vmcnt(12)
    v_mov_b32 v20, 1
    ds_write_b32 v124, v20 offset:16
    s_mov_b32 m0, 0
    s_nop 0
    buffer_load_dwordx4 v9, s[12:15], s57 offen offset:0 nt lds
    buffer_load_dwordx4 v10, s[12:15], s57 offen offset:1024 nt lds
    buffer_load_dwordx4 v11, s[12:15], s57 offen offset:2048 nt lds
    buffer_load_dwordx4 v12, s[12:15], s57 offen offset:3072 nt lds
    s_add_u32 s57, s57, 131072
    s_waitcnt vmcnt(12)
    v_mov_b32 v20, 2
    ds_write_b32 v124, v20 offset:16
    s_mov_b32 m0, 4096
    s_nop 0
    buffer_load_dwordx4 v9, s[12:15], s57 offen offset:0 nt lds
    buffer_load_dwordx4 v10, s[12:15], s57 offen offset:1024 nt lds
    buffer_load_dwordx4 v11, s[12:15], s57 offen offset:2048 nt lds
    buffer_load_dwordx4 v12, s[12:15], s57 offen offset:3072 nt lds
    s_add_u32 s57, s57, 131072
    s_waitcnt vmcnt(12)
    v_mov_b32 v20, 3
    ds_write_b32 v124, v20 offset:16
    s_mov_b32 m0, 8192
    s_nop 0
    buffer_load_dwordx4 v9, s[12:15], s57 offen offset:0 nt lds
    buffer_load_dwordx4 v10, s[12:15], s57 offen offset:1024 nt lds
    buffer_load_dwordx4 v11, s[12:15], s57 offen offset:2048 nt lds
    buffer_load_dwordx4 v12, s[12:15], s57 offen offset:3072 nt lds
    s_add_u32 s57, s57, 131072
    s_waitcnt vmcnt(12)
    v_mov_b32 v20, 4
    ds_write_b32 v124, v20 offset:16
    s_mov_b32 m0, 12288
    s_nop 0
    buffer_load_dwordx4 v9, s[12:15], s57 offen offset:0 nt lds
    buffer_load_dwordx4 v10, s[12:15], s57 offen offset:1024 nt lds
    buffer_load_dwordx4 v11, s[12:15], s57 offen offset:2048 nt lds
    buffer_load_dwordx4 v12, s[12:15], s57 offen offset:3072 nt lds
    s_add_u32 s57, s57, 131072
    s_mov_b32 m0, 16384
    s_nop 0
    buffer_load_dwordx4 v9, s[12:15], s57 offen offset:0 nt lds
    buffer_load_dwordx4 v10, s[12:15], s57 offen offset:1024 nt lds
    buffer_load_dwordx4 v11, s[12:15], s57 offen offset:2048 nt lds
    buffer_load_dwordx4 v12, s[12:15], s57 offen offset:3072 nt lds
    s_add_u32 s57, s57, 131072
    s_waitcnt vmcnt(16)
    v_mov_b32 v20, 5
    ds_write_b32 v124, v20 offset:16
    s_mov_b32 m0, 20480
    s_nop 0
    buffer_load_dwordx4 v9, s[12:15], s57 offen offset:0 nt lds
    buffer_load_dwordx4 v10, s[12:15], s57 offen offset:1024 nt lds
    buffer_load_dwordx4 v11, s[12:15], s57 offen offset:2048 nt lds
    buffer_load_dwordx4 v12, s[12:15], s57 offen offset:3072 nt lds
    s_add_u32 s57, s57, 131072
    s_waitcnt vmcnt(16)
    v_mov_b32 v20, 6
    ds_write_b32 v124, v20 offset:16
    s_mov_b32 m0, 24576
    s_nop 0
    buffer_load_dwordx4 v9, s[12:15], s57 offen offset:0 nt lds
    buffer_load_dwordx4 v10, s[12:15], s57 offen offset:1024 nt lds
    buffer_load_dwordx4 v11, s[12:15], s57 offen offset:2048 nt lds
    buffer_load_dwordx4 v12, s[12:15], s57 offen offset:3072 nt lds
    s_add_u32 s57, s57, 131072
    s_waitcnt vmcnt(16)
    v_mov_b32 v20, 7
    ds_write_b32 v124, v20 offset:16
    s_mov_b32 m0, 28672
    s_nop 0
    buffer_load_dwordx4 v9, s[12:15], s57 offen offset:0 nt lds
    buffer_load_dwordx4 v10, s[12:15], s57 offen offset:1024 nt lds
    buffer_load_dwordx4 v11, s[12:15], s57 offen offset:2048 nt lds
    buffer_load_dwordx4 v12, s[12:15], s57 offen offset:3072 nt lds
    s_add_u32 s57, s57, 131072
    s_waitcnt vmcnt(16)
    v_mov_b32 v20, 8
    ds_write_b32 v124, v20 offset:16
    s_mov_b32 m0, 32768
    s_nop 0
    buffer_load_dwordx4 v13, s[16:19], s58 offen offset:0 nt lds
    buffer_load_dwordx4 v14, s[16:19], s58 offen offset:1024 nt lds
    buffer_load_dwordx4 v13, s[16:19], s58 offen offset:2048 nt lds
    buffer_load_dwordx4 v14, s[16:19], s58 offen offset:3072 nt lds
    s_add_u32 s58, s58, 131072
    s_waitcnt vmcnt(16)
    v_mov_b32 v20, 9
    ds_write_b32 v124, v20 offset:16
    s_mov_b32 m0, 36864
    s_nop 0
    buffer_load_dwordx4 v13, s[16:19], s58 offen offset:0 nt lds
    buffer_load_dwordx4 v14, s[16:19], s58 offen offset:1024 nt lds
    buffer_load_dwordx4 v13, s[16:19], s58 offen offset:2048 nt lds
    buffer_load_dwordx4 v14, s[16:19], s58 offen offset:3072 nt lds
    s_add_u32 s58, s58, 131072
    s_waitcnt vmcnt(16)
    v_mov_b32 v20, 10
    ds_write_b32 v124, v20 offset:16
    s_mov_b32 m0, 40960
    s_nop 0
    buffer_load_dwordx4 v13, s[16:19], s58 offen offset:0 nt lds
    buffer_load_dwordx4 v14, s[16:19], s58 offen offset:1024 nt lds
    buffer_load_dwordx4 v13, s[16:19], s58 offen offset:2048 nt lds
    buffer_load_dwordx4 v14, s[16:19], s58 offen offset:3072 nt lds
    s_add_u32 s58, s58, 131072
    s_waitcnt vmcnt(16)
    v_mov_b32 v20, 11
    ds_write_b32 v124, v20 offset:16
    s_mov_b32 m0, 45056
    s_nop 0
    buffer_load_dwordx4 v13, s[16:19], s58 offen offset:0 nt lds
    buffer_load_dwordx4 v14, s[16:19], s58 offen offset:1024 nt lds
    buffer_load_dwordx4 v13, s[16:19], s58 offen offset:2048 nt lds
    buffer_load_dwordx4 v14, s[16:19], s58 offen offset:3072 nt lds
    s_add_u32 s58, s58, 131072
    s_mov_b32 m0, 49152
    s_nop 0
    buffer_load_dwordx4 v13, s[16:19], s58 offen offset:0 nt lds
    buffer_load_dwordx4 v14, s[16:19], s58 offen offset:1024 nt lds
    buffer_load_dwordx4 v13, s[16:19], s58 offen offset:2048 nt lds
    buffer_load_dwordx4 v14, s[16:19], s58 offen offset:3072 nt lds
    s_add_u32 s58, s58, 131072
    s_mov_b32 m0, 53248
    s_nop 0
    buffer_load_dwordx4 v13, s[16:19], s58 offen offset:0 nt lds
    buffer_load_dwordx4 v14, s[16:19], s58 offen offset:1024 nt lds
    buffer_load_dwordx4 v13, s[16:19], s58 offen offset:2048 nt lds
    buffer_load_dwordx4 v14, s[16:19], s58 offen offset:3072 nt lds
    s_add_u32 s58, s58, 131072
    s_waitcnt vmcnt(24)
    v_mov_b32 v20, 12
    ds_write_b32 v124, v20 offset:16
    s_mov_b32 m0, 57344
    s_nop 0
    buffer_load_dwordx4 v13, s[16:19], s58 offen offset:0 nt lds
    buffer_load_dwordx4 v14, s[16:19], s58 offen offset:1024 nt lds
    buffer_load_dwordx4 v13, s[16:19], s58 offen offset:2048 nt lds
    buffer_load_dwordx4 v14, s[16:19], s58 offen offset:3072 nt lds
    s_add_u32 s58, s58, 131072
    s_waitcnt vmcnt(24)
    v_mov_b32 v20, 13
    ds_write_b32 v124, v20 offset:16
    s_mov_b32 m0, 61440
    s_nop 0
    buffer_load_dwordx4 v13, s[16:19], s58 offen offset:0 nt lds
    buffer_load_dwordx4 v14, s[16:19], s58 offen offset:1024 nt lds
    buffer_load_dwordx4 v13, s[16:19], s58 offen offset:2048 nt lds
    buffer_load_dwordx4 v14, s[16:19], s58 offen offset:3072 nt lds
    s_add_u32 s58, s58, 131072
    s_mov_b32 s53, 1048576
Lw_17:
    ds_read_b32 v123, v124 offset:32
    s_sub_u32 s53, s53, 1
    s_cbranch_scc1 Lwd_18
    s_waitcnt lgkmcnt(0)
    v_cmp_gt_u32 vcc, 1, v123
    s_cbranch_vccnz Lw_17
Lwd_18:
    s_waitcnt vmcnt(24)
    v_mov_b32 v20, 14
    ds_write_b32 v124, v20 offset:16
    s_waitcnt vmcnt(20)
    v_mov_b32 v20, 15
    ds_write_b32 v124, v20 offset:16
    s_mov_b32 m0, 98304
    s_nop 0
    buffer_load_dwordx4 v5, s[24:27], s54 offen offset:0 nt lds
    buffer_load_dwordx4 v6, s[24:27], s54 offen offset:1024 nt lds
    buffer_load_dwordx4 v7, s[24:27], s54 offen offset:2048 nt lds
    buffer_load_dwordx4 v8, s[24:27], s54 offen offset:3072 nt lds
    s_add_u32 s54, s54, 16384
    s_waitcnt vmcnt(20)
    v_mov_b32 v20, 16
    ds_write_b32 v124, v20 offset:16
    s_mov_b32 m0, 102400
    s_nop 0
    buffer_load_dwordx4 v5, s[24:27], s54 offen offset:0 nt lds
    buffer_load_dwordx4 v6, s[24:27], s54 offen offset:1024 nt lds
    buffer_load_dwordx4 v7, s[24:27], s54 offen offset:2048 nt lds
    buffer_load_dwordx4 v8, s[24:27], s54 offen offset:3072 nt lds
    s_add_u32 s54, s54, 114688
    s_waitcnt vmcnt(20)
    v_mov_b32 v20, 17
    ds_write_b32 v124, v20 offset:16
    s_mov_b32 m0, 106496
    s_nop 0
    buffer_load_dwordx4 v5, s[24:27], s54 offen offset:0 nt lds
    buffer_load_dwordx4 v6, s[24:27], s54 offen offset:1024 nt lds
    buffer_load_dwordx4 v7, s[24:27], s54 offen offset:2048 nt lds
    buffer_load_dwordx4 v8, s[24:27], s54 offen offset:3072 nt lds
    s_add_u32 s54, s54, 16384
    s_waitcnt vmcnt(20)
    v_mov_b32 v20, 18
    ds_write_b32 v124, v20 offset:16
    s_mov_b32 m0, 110592
    s_nop 0
    buffer_load_dwordx4 v5, s[24:27], s54 offen offset:0 nt lds
    buffer_load_dwordx4 v6, s[24:27], s54 offen offset:1024 nt lds
    buffer_load_dwordx4 v7, s[24:27], s54 offen offset:2048 nt lds
    buffer_load_dwordx4 v8, s[24:27], s54 offen offset:3072 nt lds
    s_add_u32 s54, s54, 16384
    s_cmp_eq_u32 s4, 7
    s_cbranch_scc1 L_load_N
    s_cmp_ge_u32 s5, 16
    s_cbranch_scc1 L_load_F
    v_lshl_add_u32 v5, v17, 10, v18
    v_xor_b32 v6, 64, v5
    v_xor_b32 v7, 128, v5
    v_xor_b32 v8, 192, v5
    v_add_u32 v6, 1024, v6
    v_add_u32 v7, 2048, v7
    v_add_u32 v8, 3072, v8
    s_lshl_b32 s54, s4, 3
    s_lshr_b32 s55, s5, 1
    s_add_u32 s54, s54, s55
    s_lshl_b32 s54, s54, 15
    s_and_b32 s55, s5, 1
    s_lshl_b32 s55, s55, 9
    s_add_u32 s54, s54, s55
    s_waitcnt vmcnt(20)
    v_mov_b32 v20, 19
    ds_write_b32 v124, v20 offset:16
    s_waitcnt vmcnt(16)
    v_mov_b32 v20, 20
    ds_write_b32 v124, v20 offset:16
    s_waitcnt vmcnt(12)
    v_mov_b32 v20, 21
    ds_write_b32 v124, v20 offset:16
    s_waitcnt vmcnt(8)
    v_mov_b32 v20, 22
    ds_write_b32 v124, v20 offset:16
    s_waitcnt vmcnt(4)
    v_mov_b32 v20, 23
    ds_write_b32 v124, v20 offset:16
    s_waitcnt vmcnt(0)
    v_mov_b32 v20, 24
    ds_write_b32 v124, v20 offset:16
    s_setprio 0
    s_barrier
    s_mov_b32 m0, 65536
    s_nop 0
    buffer_load_dwordx4 v5, s[36:39], s54 offen offset:0 nt lds
    buffer_load_dwordx4 v6, s[36:39], s54 offen offset:1024 nt lds
    buffer_load_dwordx4 v7, s[36:39], s54 offen offset:2048 nt lds
    buffer_load_dwordx4 v8, s[36:39], s54 offen offset:3072 nt lds
    s_add_u32 s54, s54, 8192
    s_mov_b32 m0, 69632
    s_nop 0
    buffer_load_dwordx4 v5, s[36:39], s54 offen offset:0 nt lds
    buffer_load_dwordx4 v6, s[36:39], s54 offen offset:1024 nt lds
    buffer_load_dwordx4 v7, s[36:39], s54 offen offset:2048 nt lds
    buffer_load_dwordx4 v8, s[36:39], s54 offen offset:3072 nt lds
    s_add_u32 s54, s54, 8192
    s_mov_b32 m0, 73728
    s_nop 0
    buffer_load_dwordx4 v5, s[36:39], s54 offen offset:0 nt lds
    buffer_load_dwordx4 v6, s[36:39], s54 offen offset:1024 nt lds
    buffer_load_dwordx4 v7, s[36:39], s54 offen offset:2048 nt lds
    buffer_load_dwordx4 v8, s[36:39], s54 offen offset:3072 nt lds
    s_add_u32 s54, s54, 8192
    s_mov_b32 m0, 77824
    s_nop 0
    buffer_load_dwordx4 v5, s[36:39], s54 offen offset:0 nt lds
    buffer_load_dwordx4 v6, s[36:39], s54 offen offset:1024 nt lds
    buffer_load_dwordx4 v7, s[36:39], s54 offen offset:2048 nt lds
    buffer_load_dwordx4 v8, s[36:39], s54 offen offset:3072 nt lds
    s_add_u32 s54, s54, 8192
    s_waitcnt vmcnt(0)
    v_mov_b32 v20, 28
    ds_write_b32 v124, v20 offset:16
    s_branch L_load_end
L_load_N:
    s_waitcnt vmcnt(20)
    v_mov_b32 v20, 19
    ds_write_b32 v124, v20 offset:16
    s_waitcnt vmcnt(16)
    v_mov_b32 v20, 20
    ds_write_b32 v124, v20 offset:16
    s_waitcnt vmcnt(12)
    v_mov_b32 v20, 21
    ds_write_b32 v124, v20 offset:16
    s_waitcnt vmcnt(8)
    v_mov_b32 v20, 22
    ds_write_b32 v124, v20 offset:16
    s_waitcnt vmcnt(4)
    v_mov_b32 v20, 23
    ds_write_b32 v124, v20 offset:16
    s_waitcnt vmcnt(0)
    v_mov_b32 v20, 24
    ds_write_b32 v124, v20 offset:16
    s_branch L_load_end
L_load_F:
    v_mul_u32_u24 v19, 3584, v17
    v_add_u32 v5, v18, v19
    v_xor_b32 v6, 64, v5
    v_xor_b32 v7, 128, v5
    v_xor_b32 v8, 192, v5
    v_add_u32 v6, 6144, v6
    v_add_u32 v7, 12288, v7
    v_add_u32 v8, 18432, v8
    s_sub_u32 s54, s5, 16
    s_mul_i32 s54, s54, 32*3584
    s_lshl_b32 s55, s4, 9
    s_add_u32 s54, s54, s55
    s_mov_b32 s55, s54
    s_mov_b32 m0, 65536
    s_nop 0
    buffer_load_dwordx4 v5, s[28:31], s54 offen offset:0 nt lds
    buffer_load_dwordx4 v6, s[28:31], s54 offen offset:1024 nt lds
    buffer_load_dwordx4 v7, s[28:31], s54 offen offset:2048 nt lds
    buffer_load_dwordx4 v8, s[28:31], s54 offen offset:3072 nt lds
    s_add_u32 s54, s54, 28672
    s_mov_b32 m0, 69632
    s_nop 0
    buffer_load_dwordx4 v5, s[28:31], s54 offen offset:0 nt lds
    buffer_load_dwordx4 v6, s[28:31], s54 offen offset:1024 nt lds
    buffer_load_dwordx4 v7, s[28:31], s54 offen offset:2048 nt lds
    buffer_load_dwordx4 v8, s[28:31], s54 offen offset:3072 nt lds
    s_add_u32 s54, s54, 28672
    s_mov_b32 m0, 73728
    s_nop 0
    buffer_load_dwordx4 v5, s[28:31], s54 offen offset:0 nt lds
    buffer_load_dwordx4 v6, s[28:31], s54 offen offset:1024 nt lds
    buffer_load_dwordx4 v7, s[28:31], s54 offen offset:2048 nt lds
    buffer_load_dwordx4 v8, s[28:31], s54 offen offset:3072 nt lds
    s_add_u32 s54, s54, 28672
    s_waitcnt vmcnt(32)
    v_mov_b32 v20, 19
    ds_write_b32 v124, v20 offset:16
    s_waitcnt vmcnt(28)
    v_mov_b32 v20, 20
    ds_write_b32 v124, v20 offset:16
    s_waitcnt vmcnt(24)
    v_mov_b32 v20, 21
    ds_write_b32 v124, v20 offset:16
    s_waitcnt vmcnt(20)
    v_mov_b32 v20, 22
    ds_write_b32 v124, v20 offset:16
    s_waitcnt vmcnt(16)
    v_mov_b32 v20, 23
    ds_write_b32 v124, v20 offset:16
    s_waitcnt vmcnt(12)
    v_mov_b32 v20, 24
    ds_write_b32 v124, v20 offset:16
    s_setprio 0
    s_barrier
    s_mov_b32 m0, 77824
    s_nop 0
    buffer_load_dwordx4 v5, s[28:31], s54 offen offset:0 nt lds
    buffer_load_dwordx4 v6, s[28:31], s54 offen offset:1024 nt lds
    buffer_load_dwordx4 v7, s[28:31], s54 offen offset:2048 nt lds
    buffer_load_dwordx4 v8, s[28:31], s54 offen offset:3072 nt lds
    s_add_u32 s54, s54, 28672
    s_mov_b32 m0, 81920
    s_nop 0
    buffer_load_dwordx4 v5, s[32:35], s55 offen offset:0 nt lds
    buffer_load_dwordx4 v6, s[32:35], s55 offen offset:1024 nt lds
    buffer_load_dwordx4 v7, s[32:35], s55 offen offset:2048 nt lds
    buffer_load_dwordx4 v8, s[32:35], s55 offen offset:3072 nt lds
    s_add_u32 s55, s55, 28672
    s_mov_b32 m0, 86016
    s_nop 0
    buffer_load_dwordx4 v5, s[32:35], s55 offen offset:0 nt lds
    buffer_load_dwordx4 v6, s[32:35], s55 offen offset:1024 nt lds
    buffer_load_dwordx4 v7, s[32:35], s55 offen offset:2048 nt lds
    buffer_load_dwordx4 v8, s[32:35], s55 offen offset:3072 nt lds
    s_add_u32 s55, s55, 28672
    s_mov_b32 m0, 90112
    s_nop 0
    buffer_load_dwordx4 v5, s[32:35], s55 offen offset:0 nt lds
    buffer_load_dwordx4 v6, s[32:35], s55 offen offset:1024 nt lds
    buffer_load_dwordx4 v7, s[32:35], s55 offen offset:2048 nt lds
    buffer_load_dwordx4 v8, s[32:35], s55 offen offset:3072 nt lds
    s_add_u32 s55, s55, 28672
    s_mov_b32 m0, 94208
    s_nop 0
    buffer_load_dwordx4 v5, s[32:35], s55 offen offset:0 nt lds
    buffer_load_dwordx4 v6, s[32:35], s55 offen offset:1024 nt lds
    buffer_load_dwordx4 v7, s[32:35], s55 offen offset:2048 nt lds
    buffer_load_dwordx4 v8, s[32:35], s55 offen offset:3072 nt lds
    s_add_u32 s55, s55, 28672
    s_waitcnt vmcnt(28)
    v_mov_b32 v20, 25
    ds_write_b32 v124, v20 offset:16
    s_waitcnt vmcnt(24)
    v_mov_b32 v20, 26
    ds_write_b32 v124, v20 offset:16
    s_waitcnt vmcnt(20)
    v_mov_b32 v20, 27
    ds_write_b32 v124, v20 offset:16
    s_waitcnt vmcnt(16)
    v_mov_b32 v20, 28
    ds_write_b32 v124, v20 offset:16
    s_waitcnt vmcnt(12)
    v_mov_b32 v20, 29
    ds_write_b32 v124, v20 offset:16
    s_waitcnt vmcnt(8)
    v_mov_b32 v20, 30
    ds_write_b32 v124, v20 offset:16
    s_waitcnt vmcnt(4)
    v_mov_b32 v20, 31
    ds_write_b32 v124, v20 offset:16
    s_waitcnt vmcnt(0)
    v_mov_b32 v20, 32
    ds_write_b32 v124, v20 offset:16
L_load_end:
    s_endpgm
L_worker:
    s_waitcnt lgkmcnt(0)
    s_cmp_lg_u32 s3, 8
    s_cbranch_scc1 L_notw
    s_cmp_lg_u32 s5, 15
    s_cbranch_scc1 L_notw
    s_mov_b64 exec, 1
    s_lshl_b32 s54, s4, 23
    s_add_u32 s54, s54, 7340032
    v_mov_b32 v5, s54
    global_load_dword v126, v5, s[66:67]
    global_load_dword v126, v5, s[68:69]
    v_mov_b32 v6, 0x800
    global_load_dword v126, v6, s[86:87]
    s_lshl_b32 s54, s4, 19
    v_mov_b32 v7, s54
    global_load_dword v126, v7, s[72:73]
    s_and_b32 s54, s5, 15
    s_mul_i32 s54, s54, 32*3584
    v_mov_b32 v9, s54
    global_load_dword v126, v9, s[76:77]
    global_load_dword v126, v9, s[78:79]
    global_load_dword v126, v9, s[80:81]
    v_mov_b32 v10, 0
    global_load_dword v126, v10, s[82:83]
    s_mov_b64 exec, -1
L_notw:
    s_mov_b64 s[44:45], s[86:87]
    s_mov_b64 s[8:9], s[64:65]
    s_load_dword s7, s[44:45], 0
    s_sub_u32 s54, s3, 2
    s_lshl_b32 s12, s4, 16
    s_lshl_b32 s56, s5, 11
    s_add_u32 s12, s12, s56
    s_lshl_b32 s56, s54, 8
    s_add_u32 s12, s12, s56
    s_add_u32 s12, s12, 131072
    v_lshlrev_b32 v88, 11, v3
    v_lshl_add_u32 v88, v4, 4, v88
    s_lshl_b32 s13, s4, 13
    s_add_u32 s13, s13, s56
    s_add_u32 s13, s13, 4096
    s_lshl_b32 s59, s54, 7
    s_add_u32 s59, s59, 115712
    v_lshl_add_u32 v89, v4, 3, s59
    v_lshrrev_b32 v55, 5, v0
    v_lshl_add_u32 v89, v55, 2, v89
    s_lshl_b32 s55, s54, 12
    v_xor_b32 v80, v3, v4
    v_lshlrev_b32 v80, 4, v80
    v_lshl_add_u32 v80, v4, 8, v80
    v_add_u32 v80, s55, v80
    v_xor_b32 v81, 64, v80
    v_xor_b32 v82, 128, v80
    v_xor_b32 v83, 192, v80
    v_and_b32 v8, 3, v0
    v_lshlrev_b32 v84, 8, v8
    v_lshl_add_u32 v84, v3, 4, v84
    v_add_u32 v84, 115712, v84
    v_lshlrev_b32 v85, 5, v8
    v_add_u32 v85, 128768, v85
    s_lshl_b32 s59, s54, 2
    v_add_u32 v86, s59, v85
    s_lshr_b32 s59, s54, 1
    s_lshl_b32 s59, s59, 10
    s_and_b32 s60, s54, 1
    s_lshl_b32 s60, s60, 3
    s_add_u32 s59, s59, s60
    s_add_u32 s59, s59, 116736
    v_add_u32 v87, s59, v2
    v_lshrrev_b32 v5, 2, v0
    v_and_b32 v6, 7, v5
    v_lshlrev_b32 v56, 8, v5
    v_lshl_add_u32 v56, v8, 3, v56
    v_xor_b32 v7, s54, v6
    v_lshl_add_u32 v7, v7, 5, v56
    v_add_u32 v9, 116736, v2
    v_lshlrev_b32 v10, 6, v4
    v_lshl_add_u32 v10, v3, 4, v10
    s_lshl_b32 s58, s54, 1
    v_xor_b32 v90, s58, v6
    v_and_b32 v13, 7, v90
    v_lshl_add_u32 v13, v13, 5, v56
    v_add_u32 v13, 98304, v13
    v_xor_b32 v14, 32, v13
    v_lshlrev_b32 v11, 5, v90
    v_lshl_add_u32 v11, v5, 9, v11
    v_lshl_add_u32 v11, v8, 3, v11
    v_add_u32 v11, 65536, v11
    v_xor_b32 v12, 32, v11
    v_lshlrev_b32 v91, 11, v3
    v_lshrrev_b32 v52, 3, v4
    v_lshl_add_u32 v91, v52, 8, v91
    v_and_b32 v53, 7, v4
    v_lshl_add_u32 v91, v53, 4, v91
    s_lshl_b32 s14, s4, 16
    s_lshl_b32 s58, s54, 13
    s_add_u32 s14, s14, s58
    s_bfe_u32 s58, s5, 0x20002
    s_lshl_b32 s58, s58, 9
    s_add_u32 s14, s14, s58
    s_lshr_b32 s58, s5, 4
    s_lshl_b32 s58, s58, 7
    s_add_u32 s14, s14, s58
    s_add_u32 s14, s14, 131072
    s_lshl_b32 s58, s54, 4
    v_lshl_add_u32 v15, v3, 2, s58
    v_bfe_u32 v53, v4, 2, 1
    v_lshl_add_u32 v15, v53, 7, v15
    v_add_u32 v15, 129024, v15
    v_lshlrev_b32 v52, 3, v52
    v_lshl_add_u32 v52, v53, 6, v52
    v_and_b32 v53, 3, v4
    v_lshl_add_u32 v52, v53, 4, v52
    v_lshl_add_u32 v52, v55, 2, v52
    v_and_b32 v53, 1, v3
    v_mul_u32_u24 v53, 144, v53
    v_add_u32 v52, v52, v53
    s_mul_i32 s58, s54, 288
    s_add_u32 s58, s58, 120832
    v_add_u32 v52, s58, v52
    v_mul_u32_u24 v53, 144, v4
    v_lshl_add_u32 v53, v3, 4, v53
    v_add_u32 v53, 120832, v53
    v_lshlrev_b32 v54, 6, v55
    v_lshl_add_u32 v54, v4, 2, v54
    s_and_b32 s15, s5, 3
    s_lshl_b32 s15, s15, 2
    s_and_b32 s58, s54, 3
    s_add_u32 s15, s15, s58
    s_lshl_b32 s15, s15, 6
    s_lshl_b32 s58, s4, 3
    s_add_u32 s15, s15, s58
    s_lshr_b32 s58, s5, 2
    s_add_u32 s15, s15, s58
    s_lshl_b32 s15, s15, 7
    s_add_u32 s15, s15, 655360
    s_lshr_b32 s58, s54, 2
    s_mul_i32 s58, s58, 0
    s_add_u32 s15, s15, s58
    s_mov_b32 s20, 0x000f000f
    s_mov_b32 s21, 0x000f000f
    s_mov_b32 s22, 0x0000ffff
    s_mov_b32 s23, 0x0000ffff
    s_mov_b32 s24, 0x00ff00ff
    s_mov_b32 s25, 0x00ff00ff
    s_mov_b32 s26, 1035273459
    s_mov_b32 s27, 1035273459
    s_mov_b32 s28, 1069066811
    s_add_u32 s29, s54, 5
    s_mov_b32 s30, 0x1111
    s_mov_b32 s31, 0x1111
    s_waitcnt lgkmcnt(0)
    s_add_u32 s7, s7, 1
    s_and_b32 s6, s7, 0xff
    v_mov_b32 v1, s6
    s_mul_i32 s51, s7, 0x9E3779B1
    s_xor_b32 s51, s51, 0x5bd1e995
    s_mul_i32 s52, s7, 0x85EBCA77
    s_xor_b32 s52, s52, 0xc2b2ae3d
    s_getreg_b32 s62, hwreg(HW_REG_XCC_ID)
    s_and_b32 s62, s62, 7
    s_lshl_b32 s62, s62, 5
    s_xor_b32 s62, s62, s6
    v_mov_b32 v121, s62
    s_mov_b32 s19, 0x200000
    s_cmp_ge_u32 s5, 16
    s_cbranch_scc1 L_fprep
    s_lshl_b32 s60, s4, 3
    s_lshr_b32 s61, s5, 1
    s_add_u32 s60, s60, s61
    s_and_b32 s61, s5, 1
    s_lshl_b32 s16, s60, 13
    s_lshl_b32 s56, s54, 10
    s_add_u32 s16, s16, s56
    s_add_u32 s16, s16, 786432
    s_lshl_b32 s56, s54, 3
    s_add_u32 s56, s56, 123392
    v_mul_u32_u24 v57, 80, v0
    v_add_u32 v57, s56, v57
    v_lshrrev_b32 v58, 3, v4
    v_lshlrev_b32 v58, 5, v58
    v_bfe_u32 v55, v4, 2, 1
    v_lshl_add_u32 v58, v55, 4, v58
    v_lshl_add_u32 v58, v3, 2, v58
    v_add_u32 v58, v58, v8
    v_mul_u32_u24 v58, 80, v58
    v_add_u32 v58, 123392, v58
    v_mov_b32 v63, 129280
    v_and_b32 v55, 1, v4
    v_lshlrev_b32 v55, 4, v55
    v_mov_b32 v56, 0xffff
    v_lshlrev_b32 v56, v55, v56
    v_lshrrev_b32 v55, 1, v4
    v_cmp_eq_u32 vcc, 0, v55
    s_nop 1
    v_cndmask_b32 v100, 0, v56, vcc
    v_cmp_eq_u32 vcc, 1, v55
    s_nop 1
    v_cndmask_b32 v101, 0, v56, vcc
    v_cmp_eq_u32 vcc, 2, v55
    s_nop 1
    v_cndmask_b32 v102, 0, v56, vcc
    v_cmp_eq_u32 vcc, 3, v55
    s_nop 1
    v_cndmask_b32 v103, 0, v56, vcc
    v_cmp_eq_u32 vcc, 4, v55
    s_nop 1
    v_cndmask_b32 v104, 0, v56, vcc
    v_cmp_eq_u32 vcc, 5, v55
    s_nop 1
    v_cndmask_b32 v105, 0, v56, vcc
    v_cmp_eq_u32 vcc, 6, v55
    s_nop 1
    v_cndmask_b32 v106, 0, v56, vcc
    v_cmp_eq_u32 vcc, 7, v55
    s_nop 1
    v_cndmask_b32 v107, 0, v56, vcc
    s_lshl_b32 s17, s61, 3
    s_add_u32 s17, s17, s54
    s_mul_i32 s17, s17, 56
    s_add_u32 s17, s17, s60
    s_lshl_b32 s17, s17, 7
    s_add_u32 s17, s17, 1310720
    v_mov_b32 v59, 0
    s_branch L_qk
L_fprep:
    s_sub_u32 s60, s5, 16
    v_and_b32 v57, 7, v0
    v_lshlrev_b32 v57, 1, v57
    v_lshrrev_b32 v58, 1, v3
    v_add_u32 v57, v57, v58
    v_mul_u32_u24 v57, 80, v57
    v_and_b32 v58, 1, v3
    v_lshl_add_u32 v57, v58, 5, v57
    s_lshl_b32 s58, s54, 2
    s_add_u32 s58, s58, 123392
    v_add_u32 v57, s58, v57
    s_lshl_b32 s16, s60, 13
    s_lshl_b32 s58, s54, 10
    s_add_u32 s16, s16, s58
    s_add_u32 s16, s16, 655360
    s_mul_i32 s18, s4, 0
    s_add_u32 s16, s16, s18
    s_mul_i32 s18, s60, 7168
    s_add_u32 s18, s18, s58
    s_add_u32 s18, s18, 1310720
    v_lshrrev_b32 v58, 1, v8
    v_lshlrev_b32 v58, 3, v58
    v_lshl_add_u32 v58, v3, 1, v58
    v_and_b32 v55, 1, v0
    v_add_u32 v58, v58, v55
    v_lshrrev_b32 v56, 3, v4
    v_lshlrev_b32 v55, 2, v58
    v_lshl_add_u32 v55, v56, 1, v55
    s_lshl_b32 s58, s60, 6
    buffer_load_ushort v60, v55, s[8:11], s58 offen
    v_mul_u32_u24 v58, 80, v58
    v_lshrrev_b32 v55, 2, v4
    v_lshl_add_u32 v58, v55, 4, v58
    v_add_u32 v58, 123392, v58
    v_lshlrev_b32 v56, 4, v56
    v_mov_b32 v62, 0xffff
    v_lshlrev_b32 v62, v56, v62
    v_cmp_eq_u32 vcc, 4, v4
    s_nop 1
    v_cndmask_b32 v100, 0, -1, vcc
    v_cmp_eq_u32 vcc, 12, v4
    s_nop 1
    v_cndmask_b32 v104, 0, -1, vcc
    v_cmp_eq_u32 vcc, 5, v4
    s_nop 1
    v_cndmask_b32 v101, 0, -1, vcc
    v_cmp_eq_u32 vcc, 13, v4
    s_nop 1
    v_cndmask_b32 v105, 0, -1, vcc
    v_cmp_eq_u32 vcc, 6, v4
    s_nop 1
    v_cndmask_b32 v102, 0, -1, vcc
    v_cmp_eq_u32 vcc, 14, v4
    s_nop 1
    v_cndmask_b32 v106, 0, -1, vcc
    v_cmp_eq_u32 vcc, 7, v4
    s_nop 1
    v_cndmask_b32 v103, 0, -1, vcc
    v_cmp_eq_u32 vcc, 15, v4
    s_nop 1
    v_cndmask_b32 v107, 0, -1, vcc
    v_mov_b32 v110, 0x3f803f80
    v_cmp_eq_u32 vcc, 0, v4
    s_nop 1
    v_cndmask_b32 v108, 0, v110, vcc
    v_cmp_eq_u32 vcc, 8, v4
    s_nop 1
    v_cndmask_b32 v109, 0, v110, vcc
    v_lshrrev_b32 v59, 1, v3
    v_lshlrev_b32 v59, 8, v59
    v_lshl_add_u32 v59, v4, 4, v59
    v_and_b32 v55, 1, v3
    v_xor_b32 v55, 1, v55
    v_lshl_add_u32 v59, v55, 3, v59
    s_lshl_b32 s17, s4, 3
    s_add_u32 s17, s17, s54
    s_lshl_b32 s17, s17, 4
    s_add_u32 s17, s17, s60
    s_lshl_b32 s17, s17, 9
    s_add_u32 s17, s17, 786432
L_qk:
    s_mov_b32 s53, 1048576
Lw_19:
    s_sleep 1
    ds_read_b32 v123, v124 offset:32
    s_sub_u32 s53, s53, 1
    s_cbranch_scc1 Lwd_20
    s_waitcnt lgkmcnt(0)
    v_cmp_gt_u32 vcc, 1, v123
    s_cbranch_vccnz Lw_19
Lwd_20:
    s_mov_b32 s63, 14
    s_sleep 4
    buffer_load_dwordx4 v[92:95], v88, s[44:47], s13 offen sc1
    s_sleep 8
    buffer_load_dwordx4 v[96:99], v88, s[44:47], s13 offen sc1
    s_sleep 8
    buffer_load_dwordx4 v[112:115], v88, s[44:47], s13 offen sc1
L_q_loop:
    s_waitcnt vmcnt(2)
    v_xor_b32 v48, v92, v121
    v_xor_b32 v49, v93, v121
    v_xor_b32 v50, v94, v121
    v_xor_b32 v51, v95, v121
    v_or3_b32 v56, v48, v49, v50
    v_bitop3_b32 v56, v56, v51, s50 bitop3:0x54
    v_cmp_ne_u32 vcc, 0, v56
    s_cbranch_vccz L_q_done
    s_sub_u32 s63, s63, 1
    s_cbranch_scc1 L_q_slow
    buffer_load_dwordx4 v[92:95], v88, s[44:47], s13 offen sc1
    s_waitcnt vmcnt(2)
    v_xor_b32 v48, v96, v121
    v_xor_b32 v49, v97, v121
    v_xor_b32 v50, v98, v121
    v_xor_b32 v51, v99, v121
    v_or3_b32 v56, v48, v49, v50
    v_bitop3_b32 v56, v56, v51, s50 bitop3:0x54
    v_cmp_ne_u32 vcc, 0, v56
    s_cbranch_vccz L_q_done
    s_sub_u32 s63, s63, 1
    s_cbranch_scc1 L_q_slow
    buffer_load_dwordx4 v[96:99], v88, s[44:47], s13 offen sc1
    s_waitcnt vmcnt(2)
    v_xor_b32 v48, v112, v121
    v_xor_b32 v49, v113, v121
    v_xor_b32 v50, v114, v121
    v_xor_b32 v51, v115, v121
    v_or3_b32 v56, v48, v49, v50
    v_bitop3_b32 v56, v56, v51, s50 bitop3:0x54
    v_cmp_ne_u32 vcc, 0, v56
    s_cbranch_vccz L_q_done
    s_sub_u32 s63, s63, 1
    s_cbranch_scc1 L_q_slow
    buffer_load_dwordx4 v[112:115], v88, s[44:47], s13 offen sc1
    s_branch L_q_loop
L_q_slow:
    ds_write_b32 v124, v125 offset:40
    s_add_u32 s13, s13, s19
    buffer_load_dwordx4 v[48:51], v88, s[44:47], s13 offen sc1
    s_mov_b32 s63, 262144
Lpc_23:
    s_waitcnt vmcnt(0)
    v_xor_b32 v48, v48, v1
    v_xor_b32 v49, v49, v1
    v_xor_b32 v50, v50, v1
    v_xor_b32 v51, v51, v1
    v_or3_b32 v56, v48, v49, v50
    v_bitop3_b32 v56, v56, v51, s50 bitop3:0x54
    v_cmp_ne_u32 vcc, 0, v56
    s_cbranch_vccnz Lpr_22
Lpd_21:
L_q_done:
    v_permlane32_swap_b32 v48, v50
    v_permlane32_swap_b32 v49, v51
    v_pk_add_f32 v[48:49], v[48:49], v[50:51]
    v_mov_b32 v50, v48
    v_mov_b32 v51, v49
    s_nop 0
    v_permlane16_swap_b32 v48, v50
    v_permlane16_swap_b32 v49, v51
    v_pk_add_f32 v[48:49], v[48:49], v[50:51]
    v_cvt_pk_bf16_f32 v48, v48, v49
    ds_write_b32 v89, v48
    s_mov_b64 exec, 1
    ds_add_u32 v124, v125 offset:0
    s_mov_b64 exec, -1
    s_mov_b32 s53, 1048576
Lw_24:
    ds_read_b32 v123, v124 offset:16
    s_sub_u32 s53, s53, 1
    s_cbranch_scc1 Lwd_25
    s_waitcnt lgkmcnt(0)
    v_cmp_gt_u32 vcc, s29, v123
    s_cbranch_vccnz Lw_24
Lwd_25:
    ds_read_b128 v[16:19], v80 offset:0
    ds_read_b128 v[20:23], v81 offset:0
    ds_read_b128 v[24:27], v82 offset:0
    ds_read_b128 v[28:31], v83 offset:0
    s_mov_b32 s53, 1048576
Lw_26:
    ds_read_b32 v123, v124 offset:0
    s_sub_u32 s53, s53, 1
    s_cbranch_scc1 Lwd_27
    s_waitcnt lgkmcnt(0)
    v_cmp_gt_u32 vcc, 8, v123
    s_cbranch_vccnz Lw_26
Lwd_27:
    ds_read_b128 v[64:67], v84 offset:0
    ds_read_b128 v[68:71], v84 offset:64
    ds_read_b128 v[72:75], v84 offset:128
    ds_read_b128 v[76:79], v84 offset:192
    ds_read_b32 v120, v124 offset:40
    s_waitcnt lgkmcnt(4)
    v_mfma_f32_16x16x32_bf16 v[48:51], v[16:19], v[64:67], 0
    s_waitcnt lgkmcnt(3)
    v_mfma_f32_16x16x32_bf16 v[48:51], v[20:23], v[68:71], v[48:51]
    s_waitcnt lgkmcnt(2)
    v_mfma_f32_16x16x32_bf16 v[48:51], v[24:27], v[72:75], v[48:51]
    s_waitcnt lgkmcnt(1)
    v_mfma_f32_16x16x32_bf16 v[48:51], v[28:31], v[76:79], v[48:51]
    s_nop 7
    v_cvt_pk_bf16_f32 v72, v48, v49
    v_cvt_pk_bf16_f32 v73, v50, v51
    v_lshlrev_b32 v64, 16, v72
    v_and_b32 v65, 0xffff0000, v72
    v_lshlrev_b32 v66, 16, v73
    v_and_b32 v67, 0xffff0000, v73
    v_pk_mul_f32 v[64:65], v[64:65], s[26:27]
    v_pk_mul_f32 v[66:67], v[66:67], s[26:27]
    v_cvt_pk_bf16_f32 v72, v64, v65
    v_cvt_pk_bf16_f32 v73, v66, v67
    v_lshlrev_b32 v64, 16, v72
    v_and_b32 v65, 0xffff0000, v72
    v_lshlrev_b32 v66, 16, v73
    v_and_b32 v67, 0xffff0000, v73
    v_max3_f32 v76, v64, v65, v66
    v_max_f32 v76, v76, v67
    v_mov_b32 v77, v76
    s_nop 1
    v_permlane16_swap_b32 v76, v77
    v_max_f32 v76, v76, v77
    v_mov_b32 v77, v76
    s_nop 1
    v_permlane32_swap_b32 v76, v77
    v_max_f32 v76, v76, v77
    ds_write_b32 v86, v76
    s_mov_b64 exec, 1
    ds_add_u32 v124, v125 offset:4
    s_mov_b64 exec, -1
    s_mov_b32 s53, 1048576
Lw_28:
    ds_read_b32 v123, v124 offset:4
    ds_read_b128 v[68:71], v85
    ds_read_b128 v[72:75], v85 offset:16
    s_sub_u32 s53, s53, 1
    s_cbranch_scc1 Lwd_29
    s_waitcnt lgkmcnt(2)
    v_cmp_gt_u32 vcc, 8, v123
    s_cbranch_vccnz Lw_28
Lwd_29:
    s_waitcnt lgkmcnt(0)
    v_max3_f32 v76, v68, v69, v70
    v_max3_f32 v77, v71, v72, v73
    v_max3_f32 v76, v76, v74, v75
    v_max_f32 v76, v76, v77
    v_mul_f32 v77, s28, v76
    v_fma_f32 v64, v64, s28, -v77
    v_fma_f32 v65, v65, s28, -v77
    v_fma_f32 v66, v66, s28, -v77
    v_fma_f32 v67, v67, s28, -v77
    v_exp_f32 v64, v64
    v_exp_f32 v65, v65
    v_exp_f32 v66, v66
    v_exp_f32 v67, v67
    v_cvt_pk_bf16_f32 v72, v64, v65
    v_cvt_pk_bf16_f32 v73, v66, v67
    ds_write_b64 v87, v[72:73]
    s_mov_b64 exec, 1
    ds_add_u32 v124, v125 offset:8
    s_mov_b64 exec, -1
    v_pk_add_f32 v[64:65], v[64:65], v[66:67]
    v_add_f32 v64, v64, v65
    v_mov_b32 v65, v64
    s_nop 1
    v_permlane16_swap_b32 v64, v65
    v_add_f32 v64, v64, v65
    v_mov_b32 v65, v64
    s_nop 1
    v_permlane32_swap_b32 v64, v65
    v_add_f32 v64, v64, v65
    ds_write_b32 v86, v64 offset:128
    s_mov_b64 exec, 1
    ds_add_u32 v124, v125 offset:12
    s_mov_b64 exec, -1
    v_readfirstlane_b32 s49, v120
    s_cmp_eq_u32 s49, 0
    s_cselect_b32 s48, 0, -1
    s_mov_b32 s53, 1048576
Lw_30:
    ds_read_b32 v123, v124 offset:8
    s_sub_u32 s53, s53, 1
    s_cbranch_scc1 Lwd_31
    s_waitcnt lgkmcnt(0)
    v_cmp_gt_u32 vcc, 8, v123
    s_cbranch_vccnz Lw_30
Lwd_31:
    ds_read_b128 v[16:19], v9 offset:0
    ds_read_b128 v[20:23], v9 offset:1024
    ds_read_b128 v[24:27], v9 offset:2048
    ds_read_b128 v[28:31], v9 offset:3072
    s_mov_b32 s53, 1048576
Lw_32:
    ds_read_b32 v123, v124 offset:16
    s_sub_u32 s53, s53, 1
    s_cbranch_scc1 Lwd_33
    s_waitcnt lgkmcnt(0)
    v_cmp_gt_u32 vcc, 18, v123
    s_cbranch_vccnz Lw_32
Lwd_33:
    ds_read_b64_tr_b16 v[32:33], v7 offset:32768
    ds_read_b64_tr_b16 v[34:35], v7 offset:36864
    ds_read_b64_tr_b16 v[36:37], v7 offset:40960
    ds_read_b64_tr_b16 v[38:39], v7 offset:45056
    ds_read_b64_tr_b16 v[40:41], v7 offset:49152
    ds_read_b64_tr_b16 v[42:43], v7 offset:53248
    s_waitcnt lgkmcnt(4)
    v_mfma_f32_16x16x32_bf16 v[48:51], v[32:35], v[16:19], 0
    s_waitcnt lgkmcnt(2)
    v_mfma_f32_16x16x32_bf16 v[48:51], v[36:39], v[20:23], v[48:51]
    s_waitcnt lgkmcnt(0)
    v_mfma_f32_16x16x32_bf16 v[48:51], v[40:43], v[24:27], v[48:51]
    s_mov_b32 s53, 1048576
Lw_34:
    ds_read_b32 v123, v124 offset:16
    ds_read_b64_tr_b16 v[44:45], v7 offset:57344
    ds_read_b64_tr_b16 v[46:47], v7 offset:61440
    s_sub_u32 s53, s53, 1
    s_cbranch_scc1 Lwd_35
    s_waitcnt lgkmcnt(2)
    v_cmp_gt_u32 vcc, 20, v123
    s_cbranch_vccnz Lw_34
Lwd_35:
    s_waitcnt lgkmcnt(0)
    v_mfma_f32_16x16x32_bf16 v[48:51], v[44:47], v[28:31], v[48:51]
    s_mov_b64 exec, s[20:21]
    s_nop 6
    v_bfi_b32 v48, s50, v48, v1
    v_bfi_b32 v49, s50, v49, v1
    v_bfi_b32 v50, s50, v50, v1
    v_bfi_b32 v51, s50, v51, v1
    buffer_store_dwordx4 v[48:51], v10, s[44:47], s12 offen
    s_cmp_eq_u32 s49, 0
    s_cbranch_scc1 Lpb_36
    s_waitcnt vmcnt(0)
    v_lshlrev_b32 v56, 1, v10
    s_lshl_b32 s62, s12, 1
    s_add_u32 s62, s62, s19
    v_mov_b32 v112, v48
    v_mov_b32 v113, s51
    v_mov_b32 v114, v49
    v_mov_b32 v115, s51
    v_mov_b32 v116, v50
    v_mov_b32 v117, s51
    v_mov_b32 v118, v51
    v_mov_b32 v119, s51
    buffer_store_dwordx4 v[112:115], v56, s[44:47], s62 offen offset:0 sc1
    buffer_store_dwordx4 v[116:119], v56, s[44:47], s62 offen offset:16 sc1
    s_waitcnt vmcnt(0)
Lpb_36:
    s_mov_b64 exec, -1
    s_mov_b32 s53, 1048576
Lw_37:
    ds_read_b32 v123, v124 offset:16
    s_sub_u32 s53, s53, 1
    s_cbranch_scc1 Lwd_38
    s_waitcnt lgkmcnt(0)
    v_cmp_gt_u32 vcc, 24, v123
    s_cbranch_vccnz Lw_37
Lwd_38:
    buffer_load_dwordx4 v[32:35], v91, s[44:47], s14 offen sc1
    s_mov_b32 s63, 262144
    ds_read_b64_tr_b16 v[16:17], v13 offset:0
    ds_read_b64_tr_b16 v[18:19], v13 offset:4096
    ds_read_b64_tr_b16 v[20:21], v13 offset:8192
    ds_read_b64_tr_b16 v[22:23], v13 offset:12288
    ds_read_b64_tr_b16 v[24:25], v14 offset:0
    ds_read_b64_tr_b16 v[26:27], v14 offset:4096
    ds_read_b64_tr_b16 v[28:29], v14 offset:8192
    ds_read_b64_tr_b16 v[30:31], v14 offset:12288
Lpc_41:
    s_waitcnt vmcnt(0)
    v_xor_b32 v32, v32, v1
    v_xor_b32 v33, v33, v1
    v_xor_b32 v34, v34, v1
    v_xor_b32 v35, v35, v1
    v_or3_b32 v56, v32, v33, v34
    v_bitop3_b32 v56, v56, v35, s50 bitop3:0x54
    v_cmp_ne_u32 vcc, 0, v56
    s_cbranch_vccnz Lpr_40
Lpd_39:
    s_mov_b32 s53, 1048576
Lw_42:
    ds_read_b32 v123, v124 offset:20
    ds_read_b32 v55, v15
    s_sub_u32 s53, s53, 1
    s_cbranch_scc1 Lwd_43
    s_waitcnt lgkmcnt(1)
    v_cmp_gt_u32 vcc, 1, v123
    s_cbranch_vccnz Lw_42
Lwd_43:
    s_waitcnt lgkmcnt(0)
    v_pk_mul_f32 v[32:33], v[32:33], v[54:55] op_sel:[0,1] op_sel_hi:[1,1]
    v_pk_mul_f32 v[34:35], v[34:35], v[54:55] op_sel:[0,1] op_sel_hi:[1,1]
    s_nop 1
    v_permlane32_swap_b32 v32, v34
    v_permlane32_swap_b32 v33, v35
    v_pk_add_f32 v[32:33], v[32:33], v[34:35]
    v_cvt_pk_bf16_f32 v32, v32, v33
    ds_write_b32 v52, v32
    s_waitcnt lgkmcnt(0)
    s_barrier
    s_cmp_ge_u32 s54, 4
    s_cbranch_scc1 L_stage2
    ds_read_b128 v[36:39], v53
    ds_read_b128 v[40:43], v53 offset:64
    s_waitcnt lgkmcnt(1)
    v_mfma_f32_16x16x32_bf16 v[44:47], v[36:39], v[16:19], 0
    v_mfma_f32_16x16x32_bf16 v[48:51], v[36:39], v[24:27], 0
    s_waitcnt lgkmcnt(0)
    v_mfma_f32_16x16x32_bf16 v[44:47], v[40:43], v[20:23], v[44:47]
    v_mfma_f32_16x16x32_bf16 v[48:51], v[40:43], v[28:31], v[48:51]
    s_nop 6
    v_pk_add_f32 v[44:45], v[44:45], v[46:47]
    v_pk_add_f32 v[48:49], v[48:49], v[50:51]
    v_add_f32 v44, v44, v45
    v_add_f32 v48, v48, v49
    s_nop 1
    v_permlane32_swap_b32 v44, v48
    v_add_f32 v44, v44, v48
    v_mov_b32 v45, v44
    s_nop 1
    v_permlane16_swap_b32 v44, v45
    v_add_f32 v44, v44, v45
    s_mov_b64 exec, s[22:23]
    v_bfi_b32 v44, s50, v44, v1
    buffer_store_dword v44, v54, s[44:47], s15 offen sc1
    s_mov_b64 exec, -1
L_stage2:
    s_cmp_ge_u32 s5, 16
    s_cbranch_scc1 L_fstage
    s_cmp_eq_u32 s4, 7
    s_cbranch_scc1 L_wend
    s_mov_b32 s53, 1048576
Lw_44:
    s_sleep 2
    ds_read_b32 v123, v124 offset:16
    s_sub_u32 s53, s53, 1
    s_cbranch_scc1 Lwd_45
    s_waitcnt lgkmcnt(0)
    v_cmp_gt_u32 vcc, 28, v123
    s_cbranch_vccnz Lw_44
Lwd_45:
    ds_read_b64_tr_b16 v[16:17], v11 offset:0
    ds_read_b64_tr_b16 v[18:19], v11 offset:8192
    ds_read_b64_tr_b16 v[20:21], v12 offset:0
    ds_read_b64_tr_b16 v[22:23], v12 offset:8192
    buffer_load_dwordx4 v[32:35], v2, s[44:47], s16 offen sc1
    s_mov_b32 s63, 262144
Lpc_48:
    s_waitcnt vmcnt(0)
    v_xor_b32 v32, v32, v1
    v_xor_b32 v33, v33, v1
    v_xor_b32 v34, v34, v1
    v_xor_b32 v35, v35, v1
    v_or3_b32 v56, v32, v33, v34
    v_bitop3_b32 v56, v56, v35, s50 bitop3:0x54
    v_cmp_ne_u32 vcc, 0, v56
    s_cbranch_vccnz Lpr_47
Lpd_46:
    v_permlane32_swap_b32 v32, v33
    v_permlane32_swap_b32 v34, v35
    v_add_f32 v32, v32, v33
    v_add_f32 v33, v34, v35
    ds_write_b64 v57, v[32:33]
    s_waitcnt lgkmcnt(0)
    s_barrier
    ds_read_b128 v[36:39], v58 offset:0
    ds_read_b128 v[40:43], v58 offset:16
    ds_read_b128 v[44:47], v58 offset:32
    ds_read_b128 v[48:51], v58 offset:48
    ds_read_b64 v[60:61], v63
    s_waitcnt lgkmcnt(3)
    v_pk_add_f32 v[36:37], v[36:37], v[38:39]
    v_pk_add_f32 v[40:41], v[40:41], v[42:43]
    s_waitcnt lgkmcnt(1)
    v_pk_add_f32 v[44:45], v[44:45], v[46:47]
    v_pk_add_f32 v[48:49], v[48:49], v[50:51]
    v_pk_add_f32 v[36:37], v[36:37], v[40:41]
    v_pk_add_f32 v[44:45], v[44:45], v[48:49]
    v_pk_add_f32 v[36:37], v[36:37], v[44:45]
    s_waitcnt lgkmcnt(0)
    v_fma_f32 v36, -v60, v37, v36
    v_mul_f32 v36, v36, v61
    v_cvt_pk_bf16_f32 v36, v36, v36
    v_and_b32 v36, 0xffff0000, v36
    s_nop 1
    v_mov_b32_dpp v37, v36 row_ror:8 row_mask:0xf bank_mask:0xf
    v_cndmask_b32 v38, v37, v36, s[24:25]
    v_mul_f32 v36, v36, v37
    v_cmp_lt_f32 vcc, 0, v38
    v_cvt_pk_bf16_f32 v36, v36, v36
    s_nop 0
    v_cndmask_b32 v36, 0, v36, vcc
    v_and_b32 v40, v36, v100
    v_and_b32 v41, v36, v101
    v_and_b32 v42, v36, v102
    v_and_b32 v43, v36, v103
    v_and_b32 v44, v36, v104
    v_and_b32 v45, v36, v105
    v_and_b32 v46, v36, v106
    v_and_b32 v47, v36, v107
    v_mfma_f32_16x16x32_bf16 v[48:51], v[40:43], v[16:19], 0
    s_nop 0
    v_mfma_f32_16x16x32_bf16 v[48:51], v[44:47], v[20:23], v[48:51]
    s_nop 7
    v_pk_add_f32 v[48:49], v[48:49], v[50:51]
    v_add_f32 v44, v48, v49
    v_mov_b32 v45, v44
    s_nop 1
    v_permlane16_swap_b32 v44, v45
    v_add_f32 v44, v44, v45
    s_mov_b64 exec, s[22:23]
    v_bfi_b32 v44, s50, v44, v1
    buffer_store_dword v44, v54, s[44:47], s17 offen sc1
    s_mov_b64 exec, -1
L_wend:
    s_endpgm
Lpr_22:
    buffer_load_dwordx4 v[48:51], v88, s[44:47], s13 offen sc1
    s_sub_u32 s63, s63, 1
    s_cbranch_scc0 Lpc_23
    s_waitcnt vmcnt(0)
    s_branch Lpd_21
Lpr_40:
    s_cmp_eq_u32 s49, 0
    s_cbranch_scc1 Lpn_49
    v_lshlrev_b32 v56, 1, v91
    s_lshl_b32 s62, s14, 1
    s_add_u32 s62, s62, s19
    buffer_load_dwordx4 v[112:115], v56, s[44:47], s62 offen sc1
    buffer_load_dwordx4 v[116:119], v56, s[44:47], s62 offen offset:16 sc1
    s_waitcnt vmcnt(0)
    v_xor_b32 v32, v112, v1
    v_xor_b32 v113, s51, v113
    v_xor_b32 v33, v114, v1
    v_xor_b32 v115, s51, v115
    v_xor_b32 v34, v116, v1
    v_xor_b32 v117, s51, v117
    v_xor_b32 v35, v118, v1
    v_xor_b32 v119, s51, v119
    v_or3_b32 v56, v113, v115, v117
    v_or_b32 v56, v56, v119
    v_cmp_ne_u32 vcc, 0, v56
    s_cbranch_vccz Lpd_39
Lpn_49:
    buffer_load_dwordx4 v[32:35], v91, s[44:47], s14 offen sc1
    s_sub_u32 s63, s63, 1
    s_cbranch_scc0 Lpc_41
    s_waitcnt vmcnt(0)
    s_branch Lpd_39
Lpr_47:
    s_sleep 1
    s_cmp_eq_u32 s49, 0
    s_cbranch_scc1 Lpn_50
    v_lshlrev_b32 v56, 1, v2
    s_lshl_b32 s62, s16, 1
    s_add_u32 s62, s62, s19
    buffer_load_dwordx4 v[112:115], v56, s[44:47], s62 offen sc1
    buffer_load_dwordx4 v[116:119], v56, s[44:47], s62 offen offset:16 sc1
    s_waitcnt vmcnt(0)
    v_xor_b32 v32, v112, v1
    v_xor_b32 v113, s51, v113
    v_xor_b32 v33, v114, v1
    v_xor_b32 v115, s51, v115
    v_xor_b32 v34, v116, v1
    v_xor_b32 v117, s51, v117
    v_xor_b32 v35, v118, v1
    v_xor_b32 v119, s51, v119
    v_or3_b32 v56, v113, v115, v117
    v_or_b32 v56, v56, v119
    v_cmp_ne_u32 vcc, 0, v56
    s_cbranch_vccz Lpd_46
Lpn_50:
    buffer_load_dwordx4 v[32:35], v2, s[44:47], s16 offen sc1
    s_sub_u32 s63, s63, 1
    s_cbranch_scc0 Lpc_48
    s_waitcnt vmcnt(0)
    s_branch Lpd_46
L_fstage:
    s_cmp_eq_u32 s4, 7
    s_cbranch_scc1 L_fin
    v_lshlrev_b32 v61, 16, v60
    s_mov_b32 s53, 1048576
Lw_51:
    s_sleep 1
    ds_read_b32 v123, v124 offset:16
    s_sub_u32 s53, s53, 1
    s_cbranch_scc1 Lwd_52
    s_waitcnt lgkmcnt(0)
    v_cmp_gt_u32 vcc, 28, v123
    s_cbranch_vccnz Lw_51
Lwd_52:
    buffer_load_dwordx4 v[32:35], v2, s[44:47], s16 offen sc1
    s_mov_b32 s63, 262144
Lpc_55:
    s_waitcnt vmcnt(0)
    v_xor_b32 v32, v32, v1
    v_xor_b32 v33, v33, v1
    v_xor_b32 v34, v34, v1
    v_xor_b32 v35, v35, v1
    v_or3_b32 v56, v32, v33, v34
    v_bitop3_b32 v56, v56, v35, s50 bitop3:0x54
    v_cmp_ne_u32 vcc, 0, v56
    s_cbranch_vccnz Lpr_54
Lpd_53:
    v_permlane32_swap_b32 v32, v34
    v_permlane32_swap_b32 v33, v35
    v_pk_add_f32 v[32:33], v[32:33], v[34:35]
    s_nop 1
    v_permlane16_swap_b32 v32, v33
    v_add_f32 v32, v32, v33
    s_nop 1
    v_add_f32_dpp v32, v32, v32 row_ror:8 row_mask:0xf bank_mask:0xf
    ds_write_b32 v57, v32
    s_waitcnt lgkmcnt(0)
    s_barrier
    ds_read_b128 v[36:39], v58
    ds_read_b64_tr_b16 v[16:17], v11 offset:0
    ds_read_b64_tr_b16 v[18:19], v11 offset:8192
    ds_read_b64_tr_b16 v[20:21], v12 offset:0
    ds_read_b64_tr_b16 v[22:23], v12 offset:8192
    ds_read_b64_tr_b16 v[24:25], v11 offset:16384
    ds_read_b64_tr_b16 v[26:27], v11 offset:24576
    ds_read_b64_tr_b16 v[28:29], v12 offset:16384
    ds_read_b64_tr_b16 v[30:31], v12 offset:24576
    s_waitcnt lgkmcnt(8)
    v_pk_add_f32 v[36:37], v[36:37], v[38:39]
    v_add_f32 v36, v36, v37
    s_nop 1
    v_add_f32_dpp v36, v36, v36 row_ror:4 row_mask:0xf bank_mask:0xf
    v_cvt_pk_bf16_f32 v36, v36, v36
    v_and_b32 v36, 0xffff0000, v36
    v_add_f32 v36, v36, v61
    v_cvt_pk_bf16_f32 v36, v36, v36
    s_nop 1
    v_mov_b32_dpp v37, v36 row_ror:8 row_mask:0xf bank_mask:0xf
    v_bfi_b32 v38, v62, v36, v37
    v_and_or_b32 v40, v38, v100, v108
    v_and_or_b32 v41, v38, v101, v108
    v_and_or_b32 v42, v38, v102, v108
    v_and_or_b32 v43, v38, v103, v108
    v_and_or_b32 v44, v38, v104, v109
    v_and_or_b32 v45, v38, v105, v109
    v_and_or_b32 v46, v38, v106, v109
    v_and_or_b32 v47, v38, v107, v109
    s_waitcnt lgkmcnt(0)
    v_mfma_f32_16x16x32_bf16 v[48:51], v[40:43], v[16:19], 0
    v_mfma_f32_16x16x32_bf16 v[76:79], v[40:43], v[24:27], 0
    v_mfma_f32_16x16x32_bf16 v[48:51], v[44:47], v[20:23], v[48:51]
    v_mfma_f32_16x16x32_bf16 v[76:79], v[44:47], v[28:31], v[76:79]
    s_nop 6
    v_pk_add_f32 v[48:49], v[48:49], v[50:51]
    v_pk_add_f32 v[76:77], v[76:77], v[78:79]
    v_add_f32 v64, v48, v49
    v_add_f32 v65, v76, v77
    v_bfi_b32 v64, s50, v64, v1
    v_bfi_b32 v65, s50, v65, v1
    buffer_store_dwordx2 v[64:65], v59, s[44:47], s17 offen
    s_cmp_eq_u32 s49, 0
    s_cbranch_scc1 Lpb_56
    s_waitcnt vmcnt(0)
    v_lshlrev_b32 v56, 1, v59
    s_lshl_b32 s62, s17, 1
    s_add_u32 s62, s62, s19
    v_mov_b32 v112, v64
    v_mov_b32 v113, s51
    v_mov_b32 v114, v65
    v_mov_b32 v115, s51
    buffer_store_dwordx4 v[112:115], v56, s[44:47], s62 offen offset:0 sc1
    s_waitcnt vmcnt(0)
Lpb_56:
    s_endpgm
Lpr_54:
    buffer_load_dwordx4 v[32:35], v2, s[44:47], s16 offen sc1
    s_sub_u32 s63, s63, 1
    s_cbranch_scc0 Lpc_55
    s_waitcnt vmcnt(0)
    s_branch Lpd_53
L_fin:
    buffer_load_dwordx4 v[32:35], v2, s[44:47], s16 offen sc1
    s_mov_b32 s63, 262144
Lpc_59:
    s_waitcnt vmcnt(0)
    v_xor_b32 v32, v32, v1
    v_xor_b32 v33, v33, v1
    v_xor_b32 v34, v34, v1
    v_xor_b32 v35, v35, v1
    v_or3_b32 v56, v32, v33, v34
    v_bitop3_b32 v56, v56, v35, s50 bitop3:0x54
    v_cmp_ne_u32 vcc, 0, v56
    s_cbranch_vccnz Lpr_58
Lpd_57:
    v_permlane32_swap_b32 v32, v34
    v_permlane32_swap_b32 v33, v35
    v_pk_add_f32 v[32:33], v[32:33], v[34:35]
    s_nop 1
    v_permlane16_swap_b32 v32, v33
    v_add_f32 v32, v32, v33
    s_nop 1
    v_add_f32_dpp v32, v32, v32 row_ror:8 row_mask:0xf bank_mask:0xf
    ds_write_b32 v57, v32
    s_waitcnt lgkmcnt(0)
    s_barrier
    s_cmp_eq_u32 s54, 7
    s_cbranch_scc1 L_wend2
    buffer_load_dwordx4 v[32:35], v2, s[44:47], s18 offen sc1
    s_mov_b32 s63, 262144
Lpc_62:
    s_waitcnt vmcnt(0)
    v_xor_b32 v32, v32, v1
    v_xor_b32 v33, v33, v1
    v_xor_b32 v34, v34, v1
    v_xor_b32 v35, v35, v1
    v_or3_b32 v56, v32, v33, v34
    v_bitop3_b32 v56, v56, v35, s50 bitop3:0x54
    v_cmp_ne_u32 vcc, 0, v56
    s_cbranch_vccnz Lpr_61
Lpd_60:
    v_permlane32_swap_b32 v32, v34
    v_permlane32_swap_b32 v33, v35
    v_pk_add_f32 v[32:33], v[32:33], v[34:35]
    s_nop 1
    v_permlane16_swap_b32 v32, v33
    v_add_f32 v32, v32, v33
    s_nop 1
    v_add_f32_dpp v32, v32, v32 row_ror:8 row_mask:0xf bank_mask:0xf
    ds_write_b32 v57, v32 offset:2048
    s_waitcnt lgkmcnt(0)
    s_barrier
L_wend2:
    s_endpgm
Lpr_58:
    buffer_load_dwordx4 v[32:35], v2, s[44:47], s16 offen sc1
    s_sub_u32 s63, s63, 1
    s_cbranch_scc0 Lpc_59
    s_waitcnt vmcnt(0)
    s_branch Lpd_57
Lpr_61:
    buffer_load_dwordx4 v[32:35], v2, s[44:47], s18 offen sc1
    s_sub_u32 s63, s63, 1
    s_cbranch_scc0 Lpc_62
    s_waitcnt vmcnt(0)
    s_branch Lpd_60
L_exit:
    s_endpgm

.section .rodata,"a"
.p2align 6
.amdhsa_kernel sequential_preLN__sliding_block_cached__glu_gated_reglu__decode_kernel
  .amdhsa_next_free_vgpr 128
  .amdhsa_next_free_sgpr 100
  .amdhsa_accum_offset 128
  .amdhsa_group_segment_fixed_size 0
  .amdhsa_kernarg_size 96
  .amdhsa_user_sgpr_count 2
  .amdhsa_user_sgpr_kernarg_segment_ptr 1
  .amdhsa_system_sgpr_workgroup_id_x 1
.end_amdhsa_kernel
```
